```python
import torch

def _softmax(x, axis=-1):
    return torch.softmax(x, dim=axis)
def _gelu(x):
    return torch.nn.functional.gelu(x, approximate="tanh")
def _silu(x):
    return torch.nn.functional.silu(x)
def _sigmoid(x):
    return torch.sigmoid(x)
def _layernorm(x, axis=-1, eps=1e-5):
    m = x.mean(dim=axis, keepdim=True)
    v = x.var(dim=axis, keepdim=True, unbiased=False)
    return (x - m) / torch.sqrt(v + eps)
def _scatter_add(tgt, idx, src, axis=0):
    return tgt.clone().index_add_(axis, idx, src)
def _segment_sum(src, seg, n):
    out = torch.zeros((n,) + src.shape[1:], dtype=src.dtype)
    return out.index_add_(0, seg, src)
def _pad(x, pw):
    flat = tuple(v for pair in reversed(pw) for v in pair)
    return torch.nn.functional.pad(x, flat)

kernel_name = 'standalone__detection_seg_fpn_lateral__vision'

def setup_inputs():

    _w = (lambda a: (lambda t: t.to(torch.bfloat16) if t.is_floating_point() else t)(torch.as_tensor(a)))
    H = W = (384 // 2) * 2
    C = 96
    k = 3
    return {
        "c_fine": _w((lambda *s: torch.randn(*s, dtype=torch.bfloat16) * 0.05)(1, H, W, C)),
        "p_coarse": _w((lambda *s: torch.randn(*s, dtype=torch.bfloat16) * 0.05)(1, H // 2, W // 2, C)),
        "w_lat": _w((lambda *s: torch.randn(*s, dtype=torch.bfloat16) * 0.05)(C, C)),
        "w_out": _w((lambda *s: torch.randn(*s, dtype=torch.bfloat16) * 0.05)(k, k, C, C)),
    }

def reference(c_fine, p_coarse, w_lat, w_out):
    B, H, W, C = c_fine.shape
    k = 3
    lat = torch.einsum("bhwc,cd->bhwd", c_fine, w_lat)
    up = (lambda x, n, axis: torch.repeat_interleave(x, n, dim=axis))((lambda x, n, axis: torch.repeat_interleave(x, n, dim=axis))(p_coarse, 2, axis=1), 2, axis=2)
    m = lat + up
    pad = k // 2
    mp = _pad(m, ((0, 0), (pad, pad), (pad, pad), (0, 0)))
    o = None
    for di in range(k):
        for dj in range(k):
            t = torch.einsum("bhwc,cd->bhwd", mp[:, di:di + H, dj:dj + W, :], w_out[di, dj])
            o = t if o is None else o + t
    return o
```

```asm
; @launch grid=(256,1,1) block=(256,1,1) lds=163840
.amdgcn_target "amdgcn-amd-amdhsa--gfx950"
.text
.globl standalone__detection_seg_fpn_lateral__vision_kernel
.p2align 8
.type standalone__detection_seg_fpn_lateral__vision_kernel,@function
standalone__detection_seg_fpn_lateral__vision_kernel:
    s_cmp_ge_u32 s2, 0x100
    s_cbranch_scc1 L_end
    s_load_dwordx4 s[36:39], s[0:1], 0
    s_load_dwordx4 s[40:43], s[0:1], 16
    s_load_dwordx2 s[44:45], s[0:1], 32
    v_and_b32 v84, 63, v0
    v_lshrrev_b32 v86, 6, v0
    v_and_b32 v88, 15, v0
    v_readfirstlane_b32 s24, v86
    v_lshrrev_b32 v85, 4, v84
    v_lshlrev_b32 v89, 4, v85
    v_lshlrev_b32 v13, 4, v84
    v_add_u32 v2, 134656, v13
    v_and_b32 v86, 1, v85
    v_mul_u32_u24 v90, 67328, v86
    v_lshrrev_b32 v86, 1, v85
    v_mul_u32_u24 v86, 800, v86
    v_add_u32 v90, v90, v86
    s_and_b32 s25, s24, 1
    s_lshr_b32 s26, s24, 1
    s_and_b32 s34, s2, 7
    s_mul_i32 s27, s34, 48
    s_lshr_b32 s34, s2, 3
    s_mul_i32 s28, s34, 12
    s_add_u32 s34, s28, s26
    s_mul_i32 s34, s34, 384
    s_add_u32 s34, s34, s27
    s_mul_i32 s29, s34, 192
    s_sub_u32 s27, s27, 1
    s_sub_u32 s28, s28, 1
    s_mul_i32 s33, s24, 4608
    s_mul_i32 s56, s25, 96
    s_mov_b32 s53, 384
    s_mov_b32 s54, 100
    s_lshl_b32 s34, s24, 4
    v_add_u32 v91, s34, v88
    v_cmp_lt_u32 vcc, 49, v91
    v_cmp_gt_u32 s[50:51], s54, v91
    s_nop 0
    v_cndmask_b32 v92, 0, 1, vcc
    v_mul_u32_u24 v86, 50, v92
    v_sub_u32 v93, v91, v86
    v_add_u32 v94, s28, v92
    v_add_u32 v95, s27, v93
    v_cmp_gt_u32 s[48:49], s53, v95
    v_mad_i32_i24 v86, v94, s53, v95
    v_mul_i32_i24 v86, 0xc0, v86
    v_add_u32 v86, v86, v89
    s_and_b64 vcc, s[48:49], s[50:51]
    v_ashrrev_i32 v94, 1, v94
    v_ashrrev_i32 v95, 1, v95
    v_mul_i32_i24 v87, 0xc0, v94
    v_add_u32 v87, v87, v95
    v_mul_i32_i24 v87, 0xc0, v87
    v_add_u32 v87, v87, v89
    v_mov_b32 v96, 0x80000000
    v_cndmask_b32 v5, v96, v86, vcc
    v_cndmask_b32 v7, v96, v87, vcc
    v_mul_u32_u24 v86, 4800, v92
    v_lshl_add_u32 v86, v93, 4, v86
    v_add_u32 v86, v86, v90
    v_mov_b32 v96, 153088
    v_cndmask_b32 v9, v96, v86, s[50:51]
    v_mov_b32 v96, 9600
    v_cndmask_b32 v11, 0, v96, s[50:51]
    s_lshl_b32 s34, s24, 4
    s_add_u32 s34, s34, 64
    v_add_u32 v91, s34, v88
    v_cmp_lt_u32 vcc, 49, v91
    v_cmp_gt_u32 s[50:51], s54, v91
    s_nop 0
    v_cndmask_b32 v92, 0, 1, vcc
    v_mul_u32_u24 v86, 50, v92
    v_sub_u32 v93, v91, v86
    v_add_u32 v94, s28, v92
    v_add_u32 v95, s27, v93
    v_cmp_gt_u32 s[48:49], s53, v95
    v_mad_i32_i24 v86, v94, s53, v95
    v_mul_i32_i24 v86, 0xc0, v86
    v_add_u32 v86, v86, v89
    s_and_b64 vcc, s[48:49], s[50:51]
    v_ashrrev_i32 v94, 1, v94
    v_ashrrev_i32 v95, 1, v95
    v_mul_i32_i24 v87, 0xc0, v94
    v_add_u32 v87, v87, v95
    v_mul_i32_i24 v87, 0xc0, v87
    v_add_u32 v87, v87, v89
    v_mov_b32 v96, 0x80000000
    v_cndmask_b32 v6, v96, v86, vcc
    v_cndmask_b32 v8, v96, v87, vcc
    v_mul_u32_u24 v86, 4800, v92
    v_lshl_add_u32 v86, v93, 4, v86
    v_add_u32 v86, v86, v90
    v_mov_b32 v96, 153088
    v_cndmask_b32 v10, v96, v86, s[50:51]
    v_mov_b32 v96, 9600
    v_cndmask_b32 v12, 0, v96, s[50:51]
    s_waitcnt lgkmcnt(0)
    s_mov_b32 s12, s40
    s_and_b32 s13, s41, 0xffff
    s_mov_b32 s14, 18432
    s_mov_b32 s15, 0x00020000
    s_add_u32 s46, s33, 0
    s_add_u32 m0, s33, 28800
    s_nop 0
    buffer_load_dwordx4 v13, s[12:15], s46 offen lds
    buffer_load_dwordx4 v13, s[12:15], s46 offen offset:1024 lds
    buffer_load_dwordx4 v13, s[12:15], s46 offen offset:2048 lds
    buffer_load_dwordx4 v13, s[12:15], s46 offen offset:3072 lds
    s_add_u32 s35, s46, 4096
    s_add_u32 m0, s33, 32896
    s_mov_b32 exec_hi, 0
    buffer_load_dwordx4 v13, s[12:15], s35 offen lds
    s_mov_b32 exec_hi, -1
    s_mov_b32 s16, s42
    s_and_b32 s17, s43, 0xffff
    s_mov_b32 s18, 165888
    s_mov_b32 s19, 0x00020000
    s_lshr_b32 s34, s2, 3
    s_and_b32 s34, s34, 7
    s_lshl_b32 s34, s34, 2
    s_add_u32 s34, s34, s24
    s_mul_i32 s34, s34, 5248
    v_lshlrev_b32 v86, 7, v84
    buffer_load_dword v248, v86, s[16:19], s34 offen
    s_mov_b32 s4, s36
    s_and_b32 s5, s37, 0xffff
    s_mov_b32 s6, 28311552
    s_mov_b32 s7, 0x00020000
    s_mov_b32 s8, s38
    s_and_b32 s9, s39, 0xffff
    s_mov_b32 s10, 7077888
    s_mov_b32 s11, 0x00020000
    buffer_load_dwordx4 v[132:135], v5, s[4:7], 0 offen
    buffer_load_dwordx4 v[136:139], v5, s[4:7], 0 offen offset:64
    buffer_load_dwordx4 v[140:143], v5, s[4:7], 0 offen offset:128
    buffer_load_dwordx4 v[144:147], v7, s[8:11], 0 offen
    buffer_load_dwordx4 v[148:151], v7, s[8:11], 0 offen offset:64
    buffer_load_dwordx4 v[152:155], v7, s[8:11], 0 offen offset:128
    v_add_u32 v5, 0x24000, v5
    v_add_u32 v7, 0x9000, v7
    buffer_load_dwordx4 v[156:159], v6, s[4:7], 0 offen
    buffer_load_dwordx4 v[160:163], v6, s[4:7], 0 offen offset:64
    buffer_load_dwordx4 v[164:167], v6, s[4:7], 0 offen offset:128
    buffer_load_dwordx4 v[168:171], v8, s[8:11], 0 offen
    buffer_load_dwordx4 v[172:175], v8, s[8:11], 0 offen offset:64
    buffer_load_dwordx4 v[176:179], v8, s[8:11], 0 offen offset:128
    v_add_u32 v6, 0x24000, v6
    v_add_u32 v8, 0x9000, v8
    s_add_u32 s46, s33, 0
    s_add_u32 m0, s33, 47232
    s_nop 0
    buffer_load_dwordx4 v13, s[16:19], s46 offen lds
    buffer_load_dwordx4 v13, s[16:19], s46 offen offset:1024 lds
    buffer_load_dwordx4 v13, s[16:19], s46 offen offset:2048 lds
    buffer_load_dwordx4 v13, s[16:19], s46 offen offset:3072 lds
    s_add_u32 s35, s46, 4096
    s_add_u32 m0, s33, 51328
    s_mov_b32 exec_hi, 0
    buffer_load_dwordx4 v13, s[16:19], s35 offen lds
    s_mov_b32 exec_hi, -1
    s_mov_b32 s20, s44
    s_and_b32 s21, s45, 0xffff
    s_mov_b32 s22, 28311552
    s_mov_b32 s23, 0x00020000
    s_mul_i32 s34, s26, 4800
    v_lshl_add_u32 v1, v88, 4, v90
    v_add_u32 v1, s34, v1
    v_mul_u32_u24 v86, 192, v88
    v_add_u32 v86, s56, v86
    v_add_u32 v3, v86, v89
    v_lshl_add_u32 v4, v85, 3, v86
    v_add_u32 v4, 64, v4
    v_bfe_u32 v86, v84, 2, 2
    v_lshl_add_u32 v86, v85, 3, v86
    v_mul_u32_u24 v86, 192, v86
    v_and_b32 v87, 3, v84
    v_lshl_add_u32 v96, v87, 4, v86
    v_add_u32 v14, s56, v96
    v_lshl_add_u32 v15, v87, 3, v86
    v_add_u32 v15, s56, v15
    v_add_u32 v15, 64, v15
    s_min_u32 s34, s24, 2
    s_mul_i32 s35, s34, 6144
    s_add_u32 s35, s35, 28800
    v_add_u32 v254, s35, v96
    s_lshl_b32 s35, s34, 10
    v_add_u32 v255, s35, v2
    s_waitcnt vmcnt(18)
    s_barrier
    ds_read_b64_tr_b16 v[16:17], v254 offset:0
    ds_read_b64_tr_b16 v[18:19], v254 offset:768
    ds_read_b64_tr_b16 v[20:21], v254 offset:8
    ds_read_b64_tr_b16 v[22:23], v254 offset:776
    buffer_load_dwordx4 v[180:183], v5, s[4:7], 0 offen
    ds_read_b64_tr_b16 v[24:25], v254 offset:64
    ds_read_b64_tr_b16 v[26:27], v254 offset:832
    ds_read_b64_tr_b16 v[28:29], v254 offset:72
    ds_read_b64_tr_b16 v[30:31], v254 offset:840
    buffer_load_dwordx4 v[184:187], v5, s[4:7], 0 offen offset:64
    ds_read_b64_tr_b16 v[32:33], v254 offset:128
    ds_read_b64_tr_b16 v[34:35], v254 offset:896
    ds_read_b64_tr_b16 v[36:37], v254 offset:136
    ds_read_b64_tr_b16 v[38:39], v254 offset:904
    buffer_load_dwordx4 v[188:191], v5, s[4:7], 0 offen offset:128
    s_waitcnt lgkmcnt(10)
    ds_write_b128 v255, v[16:19] offset:0
    s_waitcnt lgkmcnt(9)
    ds_write_b128 v255, v[20:23] offset:3072
    s_waitcnt lgkmcnt(8)
    ds_write_b128 v255, v[24:27] offset:6144
    s_waitcnt lgkmcnt(7)
    ds_write_b128 v255, v[28:31] offset:9216
    buffer_load_dwordx4 v[192:195], v7, s[8:11], 0 offen
    s_waitcnt lgkmcnt(6)
    ds_write_b128 v255, v[32:35] offset:12288
    s_waitcnt lgkmcnt(5)
    ds_write_b128 v255, v[36:39] offset:15360
    s_waitcnt vmcnt(17)
    v_lshlrev_b32 v84, 16, v144
    v_and_b32 v85, 0xffff0000, v144
    buffer_load_dwordx4 v[196:199], v7, s[8:11], 0 offen offset:64
    v_lshlrev_b32 v86, 16, v145
    v_and_b32 v87, 0xffff0000, v145
    v_lshlrev_b32 v88, 16, v146
    v_and_b32 v89, 0xffff0000, v146
    buffer_load_dwordx4 v[200:203], v7, s[8:11], 0 offen offset:128
    v_lshlrev_b32 v90, 16, v147
    v_and_b32 v91, 0xffff0000, v147
    s_waitcnt vmcnt(18)
    v_lshlrev_b32 v92, 16, v148
    v_and_b32 v93, 0xffff0000, v148
    v_add_u32 v5, 0x24000, v5
    v_lshlrev_b32 v94, 16, v149
    v_and_b32 v95, 0xffff0000, v149
    v_lshlrev_b32 v96, 16, v150
    v_and_b32 v97, 0xffff0000, v150
    v_add_u32 v7, 0x9000, v7
    v_lshlrev_b32 v98, 16, v151
    v_and_b32 v99, 0xffff0000, v151
    s_waitcnt vmcnt(17)
    v_lshlrev_b32 v100, 16, v152
    v_and_b32 v101, 0xffff0000, v152
    buffer_load_dwordx4 v[204:207], v6, s[4:7], 0 offen
    v_lshlrev_b32 v102, 16, v153
    v_and_b32 v103, 0xffff0000, v153
    v_lshlrev_b32 v104, 16, v154
    v_and_b32 v105, 0xffff0000, v154
    buffer_load_dwordx4 v[208:211], v6, s[4:7], 0 offen offset:64
    v_lshlrev_b32 v106, 16, v155
    v_and_b32 v107, 0xffff0000, v155
    s_waitcnt vmcnt(15)
    v_lshlrev_b32 v108, 16, v168
    v_and_b32 v109, 0xffff0000, v168
    buffer_load_dwordx4 v[212:215], v6, s[4:7], 0 offen offset:128
    v_lshlrev_b32 v110, 16, v169
    v_and_b32 v111, 0xffff0000, v169
    v_lshlrev_b32 v112, 16, v170
    v_and_b32 v113, 0xffff0000, v170
    buffer_load_dwordx4 v[216:219], v8, s[8:11], 0 offen
    v_lshlrev_b32 v114, 16, v171
    v_and_b32 v115, 0xffff0000, v171
    s_waitcnt vmcnt(16)
    v_lshlrev_b32 v116, 16, v172
    v_and_b32 v117, 0xffff0000, v172
    buffer_load_dwordx4 v[220:223], v8, s[8:11], 0 offen offset:64
    v_lshlrev_b32 v118, 16, v173
    v_and_b32 v119, 0xffff0000, v173
    v_lshlrev_b32 v120, 16, v174
    v_and_b32 v121, 0xffff0000, v174
    buffer_load_dwordx4 v[224:227], v8, s[8:11], 0 offen offset:128
    v_lshlrev_b32 v122, 16, v175
    v_and_b32 v123, 0xffff0000, v175
    s_waitcnt vmcnt(17)
    v_lshlrev_b32 v124, 16, v176
    v_and_b32 v125, 0xffff0000, v176
    v_add_u32 v6, 0x24000, v6
    v_lshlrev_b32 v126, 16, v177
    v_and_b32 v127, 0xffff0000, v177
    v_lshlrev_b32 v128, 16, v178
    v_and_b32 v129, 0xffff0000, v178
    v_add_u32 v8, 0x9000, v8
    v_lshlrev_b32 v130, 16, v179
    v_and_b32 v131, 0xffff0000, v179
    s_waitcnt vmcnt(12) lgkmcnt(0)
    s_barrier
    ds_read_b128 v[16:19], v2 offset:0
    ds_read_b128 v[20:23], v2 offset:3072
    ds_read_b128 v[24:27], v2 offset:6144
    ds_read_b128 v[28:31], v2 offset:9216
    ds_read_b128 v[32:35], v2 offset:12288
    ds_read_b128 v[36:39], v2 offset:15360
    ds_read_b128 v[40:43], v2 offset:1024
    s_waitcnt lgkmcnt(6)
    v_mfma_f32_16x16x32_bf16 v[84:87], v[16:19], v[132:135], v[84:87]
    ds_read_b128 v[44:47], v2 offset:4096
    v_add_u32 v254, 47232, v14
    s_add_u32 s46, s33, 18432
    v_mfma_f32_16x16x32_bf16 v[108:111], v[16:19], v[156:159], v[108:111]
    v_add_u32 v255, 47232, v15
    s_waitcnt lgkmcnt(6)
    v_mfma_f32_16x16x32_bf16 v[88:91], v[20:23], v[132:135], v[88:91]
    ds_read_b128 v[16:19], v2 offset:7168
    s_add_u32 m0, s33, 96128
    v_mfma_f32_16x16x32_bf16 v[112:115], v[20:23], v[156:159], v[112:115]
    ds_read_b64_tr_b16 a[0:1], v254 offset:0
    s_waitcnt lgkmcnt(7)
    v_mfma_f32_16x16x32_bf16 v[92:95], v[24:27], v[132:135], v[92:95]
    ds_read_b128 v[20:23], v2 offset:10240
    ds_read_b64_tr_b16 a[2:3], v254 offset:768
    buffer_load_dwordx4 v13, s[16:19], s46 offen lds
    v_mfma_f32_16x16x32_bf16 v[116:119], v[24:27], v[156:159], v[116:119]
    s_waitcnt lgkmcnt(8)
    v_mfma_f32_16x16x32_bf16 v[96:99], v[28:31], v[132:135], v[96:99]
    ds_read_b128 v[24:27], v2 offset:13312
    ds_read_b64_tr_b16 a[4:5], v254 offset:8
    buffer_load_dwordx4 v13, s[16:19], s46 offen offset:1024 lds
    v_mfma_f32_16x16x32_bf16 v[120:123], v[28:31], v[156:159], v[120:123]
    ds_read_b64_tr_b16 a[6:7], v254 offset:776
    s_waitcnt lgkmcnt(10)
    v_mfma_f32_16x16x32_bf16 v[100:103], v[32:35], v[132:135], v[100:103]
    ds_read_b128 v[28:31], v2 offset:16384
    buffer_load_dwordx4 v13, s[16:19], s46 offen offset:2048 lds
    v_mfma_f32_16x16x32_bf16 v[124:127], v[32:35], v[156:159], v[124:127]
    ds_read_b64_tr_b16 a[8:9], v255 offset:0
    s_waitcnt lgkmcnt(11)
    v_mfma_f32_16x16x32_bf16 v[104:107], v[36:39], v[132:135], v[104:107]
    ds_read_b128 v[32:35], v2 offset:2048
    ds_read_b64_tr_b16 a[10:11], v255 offset:768
    buffer_load_dwordx4 v13, s[16:19], s46 offen offset:3072 lds
    v_mfma_f32_16x16x32_bf16 v[128:131], v[36:39], v[156:159], v[128:131]
    s_waitcnt lgkmcnt(12)
    v_mfma_f32_16x16x32_bf16 v[84:87], v[40:43], v[136:139], v[84:87]
    ds_read_b128 v[36:39], v2 offset:5120
    ds_read_b64_tr_b16 a[12:13], v254 offset:6144
    s_add_u32 s35, s46, 4096
    v_mfma_f32_16x16x32_bf16 v[108:111], v[40:43], v[160:163], v[108:111]
    ds_read_b64_tr_b16 a[14:15], v254 offset:6912
    s_waitcnt lgkmcnt(14)
    v_mfma_f32_16x16x32_bf16 v[88:91], v[44:47], v[136:139], v[88:91]
    ds_read_b128 v[40:43], v2 offset:8192
    s_add_u32 m0, s33, 100224
    v_mfma_f32_16x16x32_bf16 v[112:115], v[44:47], v[160:163], v[112:115]
    ds_read_b64_tr_b16 a[16:17], v254 offset:6152
    s_waitcnt lgkmcnt(15)
    v_mfma_f32_16x16x32_bf16 v[92:95], v[16:19], v[136:139], v[92:95]
    ds_read_b128 v[44:47], v2 offset:11264
    s_mov_b32 exec_hi, 0
    buffer_load_dwordx4 v13, s[16:19], s35 offen lds
    s_mov_b32 exec_hi, -1
    v_mfma_f32_16x16x32_bf16 v[116:119], v[16:19], v[160:163], v[116:119]
    ds_read_b64_tr_b16 a[18:19], v254 offset:6920
    s_waitcnt lgkmcnt(15)
    v_mfma_f32_16x16x32_bf16 v[96:99], v[20:23], v[136:139], v[96:99]
    ds_read_b128 v[16:19], v2 offset:14336
    ds_read_b64_tr_b16 a[20:21], v255 offset:6144
    s_add_u32 s46, s33, 36864
    v_mfma_f32_16x16x32_bf16 v[120:123], v[20:23], v[160:163], v[120:123]
    s_waitcnt lgkmcnt(15)
    v_mfma_f32_16x16x32_bf16 v[100:103], v[24:27], v[136:139], v[100:103]
    ds_read_b128 v[20:23], v2 offset:17408
    ds_read_b64_tr_b16 a[22:23], v255 offset:6912
    s_add_u32 m0, s33, 114560
    v_mfma_f32_16x16x32_bf16 v[124:127], v[24:27], v[160:163], v[124:127]
    ds_read_b64_tr_b16 a[24:25], v254 offset:12288
    s_waitcnt lgkmcnt(15)
    v_mfma_f32_16x16x32_bf16 v[104:107], v[28:31], v[136:139], v[104:107]
    buffer_load_dwordx4 v13, s[16:19], s46 offen lds
    v_mfma_f32_16x16x32_bf16 v[128:131], v[28:31], v[160:163], v[128:131]
    ds_read_b64_tr_b16 a[26:27], v254 offset:13056
    s_waitcnt lgkmcnt(14)
    v_mfma_f32_16x16x32_bf16 v[84:87], v[32:35], v[140:143], v[84:87]
    ds_read_b64_tr_b16 a[28:29], v254 offset:12296
    buffer_load_dwordx4 v13, s[16:19], s46 offen offset:1024 lds
    v_mfma_f32_16x16x32_bf16 v[108:111], v[32:35], v[164:167], v[108:111]
    s_waitcnt lgkmcnt(13)
    v_mfma_f32_16x16x32_bf16 v[88:91], v[36:39], v[140:143], v[88:91]
    ds_read_b64_tr_b16 a[30:31], v254 offset:13064
    buffer_load_dwordx4 v13, s[16:19], s46 offen offset:2048 lds
    v_mfma_f32_16x16x32_bf16 v[112:115], v[36:39], v[164:167], v[112:115]
    ds_read_b64_tr_b16 a[32:33], v255 offset:12288
    s_waitcnt lgkmcnt(12)
    v_mfma_f32_16x16x32_bf16 v[92:95], v[40:43], v[140:143], v[92:95]
    buffer_load_dwordx4 v13, s[16:19], s46 offen offset:3072 lds
    v_mfma_f32_16x16x32_bf16 v[116:119], v[40:43], v[164:167], v[116:119]
    ds_read_b64_tr_b16 a[34:35], v255 offset:13056
    s_waitcnt lgkmcnt(11)
    v_mfma_f32_16x16x32_bf16 v[96:99], v[44:47], v[140:143], v[96:99]
    s_add_u32 s35, s46, 4096
    v_mfma_f32_16x16x32_bf16 v[120:123], v[44:47], v[164:167], v[120:123]
    s_waitcnt lgkmcnt(9)
    v_mfma_f32_16x16x32_bf16 v[100:103], v[16:19], v[140:143], v[100:103]
    s_add_u32 m0, s33, 118656
    v_mfma_f32_16x16x32_bf16 v[124:127], v[16:19], v[164:167], v[124:127]
    s_waitcnt lgkmcnt(7)
    v_mfma_f32_16x16x32_bf16 v[104:107], v[20:23], v[140:143], v[104:107]
    s_mov_b32 exec_hi, 0
    buffer_load_dwordx4 v13, s[16:19], s35 offen lds
    s_mov_b32 exec_hi, -1
    v_mfma_f32_16x16x32_bf16 v[128:131], v[20:23], v[164:167], v[128:131]
    v_cvt_pk_bf16_f32 v84, v84, v85
    v_cvt_pk_bf16_f32 v85, v86, v87
    v_cvt_pk_bf16_f32 v86, v88, v89
    v_cvt_pk_bf16_f32 v87, v90, v91
    ds_write_b128 v9, v[84:87] offset:0
    v_cvt_pk_bf16_f32 v92, v92, v93
    v_cvt_pk_bf16_f32 v93, v94, v95
    v_cvt_pk_bf16_f32 v94, v96, v97
    v_cvt_pk_bf16_f32 v95, v98, v99
    ds_write_b128 v9, v[92:95] offset:1600
    v_cvt_pk_bf16_f32 v100, v100, v101
    v_cvt_pk_bf16_f32 v101, v102, v103
    v_cvt_pk_bf16_f32 v102, v104, v105
    v_cvt_pk_bf16_f32 v103, v106, v107
    ds_write_b128 v9, v[100:103] offset:3200
    v_add_u32 v9, v9, v11
    v_cvt_pk_bf16_f32 v108, v108, v109
    v_cvt_pk_bf16_f32 v109, v110, v111
    v_cvt_pk_bf16_f32 v110, v112, v113
    v_cvt_pk_bf16_f32 v111, v114, v115
    ds_write_b128 v10, v[108:111] offset:0
    v_cvt_pk_bf16_f32 v116, v116, v117
    v_cvt_pk_bf16_f32 v117, v118, v119
    v_cvt_pk_bf16_f32 v118, v120, v121
    v_cvt_pk_bf16_f32 v119, v122, v123
    ds_write_b128 v10, v[116:119] offset:1600
    v_cvt_pk_bf16_f32 v124, v124, v125
    v_cvt_pk_bf16_f32 v125, v126, v127
    v_cvt_pk_bf16_f32 v126, v128, v129
    v_cvt_pk_bf16_f32 v127, v130, v131
    ds_write_b128 v10, v[124:127] offset:3200
    v_add_u32 v10, v10, v12
    s_mov_b32 s31, 0
    s_waitcnt lgkmcnt(0)
    s_barrier
    s_add_u32 s47, s29, 3072
    ds_read_b128 v[16:19], v1 offset:0
    ds_read_b128 v[20:23], v1 offset:1600
    ds_read_b128 v[24:27], v1 offset:3200
    ds_read_b128 v[28:31], v1 offset:256
    ds_read_b128 v[32:35], v1 offset:1856
    ds_read_b128 v[36:39], v1 offset:3456
    ds_read_b128 v[40:43], v1 offset:512
    s_waitcnt lgkmcnt(6)
    v_mfma_f32_16x16x32_bf16 v[48:51], a[0:3], v[16:19], 0
    ds_read_b128 v[44:47], v1 offset:2112
    v_mfma_f32_16x16x32_bf16 v[52:55], a[4:7], v[16:19], 0
    s_waitcnt vmcnt(18)
    v_lshlrev_b32 v84, 16, v192
    v_and_b32 v85, 0xffff0000, v192
    v_mfma_f32_16x16x32_bf16 v[56:59], a[8:11], v[16:19], 0
    s_waitcnt vmcnt(5)
    s_barrier
    v_add_u32 v254, 96128, v14
    v_lshlrev_b32 v86, 16, v193
    v_and_b32 v87, 0xffff0000, v193
    s_waitcnt lgkmcnt(6)
    v_mfma_f32_16x16x32_bf16 v[48:51], a[12:15], v[20:23], v[48:51]
    ds_read_b128 v[16:19], v1 offset:3712
    v_add_u32 v255, 96128, v15
    s_add_u32 s46, s33, 55296
    v_lshlrev_b32 v88, 16, v194
    v_and_b32 v89, 0xffff0000, v194
    v_mfma_f32_16x16x32_bf16 v[52:55], a[16:19], v[20:23], v[52:55]
    ds_read_b64_tr_b16 a[36:37], v254 offset:0
    v_lshlrev_b32 v90, 16, v195
    v_and_b32 v91, 0xffff0000, v195
    v_mfma_f32_16x16x32_bf16 v[56:59], a[20:23], v[20:23], v[56:59]
    ds_read_b64_tr_b16 a[38:39], v254 offset:768
    s_add_u32 m0, s33, 28800
    v_lshlrev_b32 v92, 16, v196
    v_and_b32 v93, 0xffff0000, v196
    s_waitcnt lgkmcnt(8)
    v_mfma_f32_16x16x32_bf16 v[48:51], a[24:27], v[24:27], v[48:51]
    ds_read_b128 v[20:23], v2 offset:0
    ds_read_b64_tr_b16 a[40:41], v254 offset:8
    v_lshlrev_b32 v94, 16, v197
    v_and_b32 v95, 0xffff0000, v197
    v_mfma_f32_16x16x32_bf16 v[52:55], a[28:31], v[24:27], v[52:55]
    ds_read_b64_tr_b16 a[42:43], v254 offset:776
    buffer_load_dwordx4 v13, s[16:19], s46 offen lds
    v_lshlrev_b32 v96, 16, v198
    v_and_b32 v97, 0xffff0000, v198
    v_mfma_f32_16x16x32_bf16 v[56:59], a[32:35], v[24:27], v[56:59]
    ds_read_b64_tr_b16 a[44:45], v255 offset:0
    v_lshlrev_b32 v98, 16, v199
    v_and_b32 v99, 0xffff0000, v199
    s_waitcnt lgkmcnt(11)
    v_mfma_f32_16x16x32_bf16 v[60:63], a[0:3], v[28:31], 0
    ds_read_b128 v[24:27], v2 offset:3072
    ds_read_b64_tr_b16 a[46:47], v255 offset:768
    buffer_load_dwordx4 v13, s[16:19], s46 offen offset:1024 lds
    v_lshlrev_b32 v100, 16, v200
    v_and_b32 v101, 0xffff0000, v200
    v_mfma_f32_16x16x32_bf16 v[64:67], a[4:7], v[28:31], 0
    ds_read_b64_tr_b16 a[48:49], v254 offset:6144
    ds_read_b64_tr_b16 a[50:51], v254 offset:6912
    v_lshlrev_b32 v102, 16, v201
    v_and_b32 v103, 0xffff0000, v201
    v_mfma_f32_16x16x32_bf16 v[68:71], a[8:11], v[28:31], 0
    buffer_load_dwordx4 v13, s[16:19], s46 offen offset:2048 lds
    v_lshlrev_b32 v104, 16, v202
    v_and_b32 v105, 0xffff0000, v202
    s_waitcnt lgkmcnt(14)
    v_mfma_f32_16x16x32_bf16 v[60:63], a[12:15], v[32:35], v[60:63]
    ds_read_b128 v[28:31], v2 offset:6144
    ds_read_b64_tr_b16 a[52:53], v254 offset:6152
    ds_read_b64_tr_b16 a[54:55], v254 offset:6920
    v_lshlrev_b32 v106, 16, v203
    v_and_b32 v107, 0xffff0000, v203
    v_mfma_f32_16x16x32_bf16 v[64:67], a[16:19], v[32:35], v[64:67]
    buffer_load_dwordx4 v13, s[16:19], s46 offen offset:3072 lds
    v_lshlrev_b32 v108, 16, v216
    v_and_b32 v109, 0xffff0000, v216
    v_mfma_f32_16x16x32_bf16 v[68:71], a[20:23], v[32:35], v[68:71]
    ds_read_b64_tr_b16 a[56:57], v255 offset:6144
    ds_read_b64_tr_b16 a[58:59], v255 offset:6912
    v_lshlrev_b32 v110, 16, v217
    v_and_b32 v111, 0xffff0000, v217
    s_waitcnt lgkmcnt(15)
    v_mfma_f32_16x16x32_bf16 v[60:63], a[24:27], v[36:39], v[60:63]
    ds_read_b128 v[32:35], v2 offset:9216
    s_add_u32 s35, s46, 4096
    v_lshlrev_b32 v112, 16, v218
    v_and_b32 v113, 0xffff0000, v218
    v_mfma_f32_16x16x32_bf16 v[64:67], a[28:31], v[36:39], v[64:67]
    ds_read_b64_tr_b16 a[60:61], v254 offset:12288
    ds_read_b64_tr_b16 a[62:63], v254 offset:13056
    v_lshlrev_b32 v114, 16, v219
    v_and_b32 v115, 0xffff0000, v219
    v_mfma_f32_16x16x32_bf16 v[68:71], a[32:35], v[36:39], v[68:71]
    s_add_u32 m0, s33, 32896
    v_lshlrev_b32 v116, 16, v220
    v_and_b32 v117, 0xffff0000, v220
    s_waitcnt lgkmcnt(15)
    v_mfma_f32_16x16x32_bf16 v[72:75], a[0:3], v[40:43], 0
    ds_read_b128 v[36:39], v2 offset:12288
    ds_read_b64_tr_b16 a[64:65], v254 offset:12296
    ds_read_b64_tr_b16 a[66:67], v254 offset:13064
    v_lshlrev_b32 v118, 16, v221
    v_and_b32 v119, 0xffff0000, v221
    v_mfma_f32_16x16x32_bf16 v[76:79], a[4:7], v[40:43], 0
    s_mov_b32 exec_hi, 0
    buffer_load_dwordx4 v13, s[16:19], s35 offen lds
    s_mov_b32 exec_hi, -1
    ds_read_b64_tr_b16 a[68:69], v255 offset:12288
    v_lshlrev_b32 v120, 16, v222
    v_and_b32 v121, 0xffff0000, v222
    v_mfma_f32_16x16x32_bf16 v[80:83], a[8:11], v[40:43], 0
    ds_read_b64_tr_b16 a[70:71], v255 offset:13056
    v_lshlrev_b32 v122, 16, v223
    v_and_b32 v123, 0xffff0000, v223
    s_waitcnt lgkmcnt(15)
    v_mfma_f32_16x16x32_bf16 v[72:75], a[12:15], v[44:47], v[72:75]
    ds_read_b128 v[40:43], v2 offset:15360
    s_add_u32 s46, s33, 73728
    s_add_u32 m0, s33, 47232
    v_lshlrev_b32 v124, 16, v224
    v_and_b32 v125, 0xffff0000, v224
    v_mfma_f32_16x16x32_bf16 v[76:79], a[16:19], v[44:47], v[76:79]
    buffer_load_dwordx4 v13, s[16:19], s46 offen lds
    v_lshlrev_b32 v126, 16, v225
    v_and_b32 v127, 0xffff0000, v225
    v_mfma_f32_16x16x32_bf16 v[80:83], a[20:23], v[44:47], v[80:83]
    buffer_load_dwordx4 v13, s[16:19], s46 offen offset:1024 lds
    buffer_load_dwordx4 v13, s[16:19], s46 offen offset:2048 lds
    v_lshlrev_b32 v128, 16, v226
    v_and_b32 v129, 0xffff0000, v226
    s_waitcnt lgkmcnt(15)
    v_mfma_f32_16x16x32_bf16 v[72:75], a[24:27], v[16:19], v[72:75]
    ds_read_b128 v[44:47], v2 offset:1024
    buffer_load_dwordx4 v13, s[16:19], s46 offen offset:3072 lds
    v_lshlrev_b32 v130, 16, v227
    v_and_b32 v131, 0xffff0000, v227
    v_mfma_f32_16x16x32_bf16 v[76:79], a[28:31], v[16:19], v[76:79]
    s_add_u32 s35, s46, 4096
    s_add_u32 m0, s33, 51328
    v_mfma_f32_16x16x32_bf16 v[80:83], a[32:35], v[16:19], v[80:83]
    s_mov_b32 exec_hi, 0
    buffer_load_dwordx4 v13, s[16:19], s35 offen lds
    s_mov_b32 exec_hi, -1
    s_waitcnt lgkmcnt(15)
    v_mfma_f32_16x16x32_bf16 v[84:87], v[20:23], v[180:183], v[84:87]
    ds_read_b128 v[16:19], v2 offset:4096
    v_mfma_f32_16x16x32_bf16 v[108:111], v[20:23], v[204:207], v[108:111]
    s_waitcnt vmcnt(10) lgkmcnt(3)
    s_barrier
    buffer_load_dwordx4 v[132:135], v5, s[4:7], 0 offen
    v_mfma_f32_16x16x32_bf16 v[88:91], v[24:27], v[180:183], v[88:91]
    ds_read_b128 v[20:23], v2 offset:7168
    v_add_u32 v254, 114560, v14
    v_mfma_f32_16x16x32_bf16 v[112:115], v[24:27], v[204:207], v[112:115]
    v_add_u32 v255, 114560, v15
    v_mfma_f32_16x16x32_bf16 v[92:95], v[28:31], v[180:183], v[92:95]
    ds_read_b128 v[24:27], v2 offset:10240
    s_add_u32 s46, s33, 92160
    v_mfma_f32_16x16x32_bf16 v[116:119], v[28:31], v[204:207], v[116:119]
    ds_read_b64_tr_b16 a[72:73], v254 offset:0
    v_mfma_f32_16x16x32_bf16 v[96:99], v[32:35], v[180:183], v[96:99]
    ds_read_b128 v[28:31], v2 offset:13312
    ds_read_b64_tr_b16 a[74:75], v254 offset:768
    v_mfma_f32_16x16x32_bf16 v[120:123], v[32:35], v[204:207], v[120:123]
    s_add_u32 m0, s33, 96128
    v_mfma_f32_16x16x32_bf16 v[100:103], v[36:39], v[180:183], v[100:103]
    ds_read_b128 v[32:35], v2 offset:16384
    ds_read_b64_tr_b16 a[76:77], v254 offset:8
    buffer_load_dwordx4 v[136:139], v5, s[4:7], 0 offen offset:64
    v_mfma_f32_16x16x32_bf16 v[124:127], v[36:39], v[204:207], v[124:127]
    ds_read_b64_tr_b16 a[78:79], v254 offset:776
    s_waitcnt lgkmcnt(10)
    v_mfma_f32_16x16x32_bf16 v[104:107], v[40:43], v[180:183], v[104:107]
    ds_read_b128 v[36:39], v2 offset:2048
    buffer_load_dwordx4 v13, s[16:19], s46 offen lds
    v_mfma_f32_16x16x32_bf16 v[128:131], v[40:43], v[204:207], v[128:131]
    ds_read_b64_tr_b16 a[80:81], v255 offset:0
    s_waitcnt lgkmcnt(11)
    v_mfma_f32_16x16x32_bf16 v[84:87], v[44:47], v[184:187], v[84:87]
    ds_read_b128 v[40:43], v2 offset:5120
    ds_read_b64_tr_b16 a[82:83], v255 offset:768
    v_mfma_f32_16x16x32_bf16 v[108:111], v[44:47], v[208:211], v[108:111]
    buffer_load_dwordx4 v13, s[16:19], s46 offen offset:1024 lds
    s_waitcnt lgkmcnt(12)
    v_mfma_f32_16x16x32_bf16 v[88:91], v[16:19], v[184:187], v[88:91]
    ds_read_b128 v[44:47], v2 offset:8192
    ds_read_b64_tr_b16 a[84:85], v254 offset:6144
    v_mfma_f32_16x16x32_bf16 v[112:115], v[16:19], v[208:211], v[112:115]
    ds_read_b64_tr_b16 a[86:87], v254 offset:6912
    s_waitcnt lgkmcnt(14)
    v_mfma_f32_16x16x32_bf16 v[92:95], v[20:23], v[184:187], v[92:95]
    ds_read_b128 v[16:19], v2 offset:11264
    buffer_load_dwordx4 v13, s[16:19], s46 offen offset:2048 lds
    buffer_load_dwordx4 v[140:143], v5, s[4:7], 0 offen offset:128
    v_mfma_f32_16x16x32_bf16 v[116:119], v[20:23], v[208:211], v[116:119]
    ds_read_b64_tr_b16 a[88:89], v254 offset:6152
    s_waitcnt lgkmcnt(15)
    v_mfma_f32_16x16x32_bf16 v[96:99], v[24:27], v[184:187], v[96:99]
    ds_read_b128 v[20:23], v2 offset:14336
    ds_read_b64_tr_b16 a[90:91], v254 offset:6920
    v_mfma_f32_16x16x32_bf16 v[120:123], v[24:27], v[208:211], v[120:123]
    buffer_load_dwordx4 v13, s[16:19], s46 offen offset:3072 lds
    s_waitcnt lgkmcnt(15)
    v_mfma_f32_16x16x32_bf16 v[100:103], v[28:31], v[184:187], v[100:103]
    ds_read_b128 v[24:27], v2 offset:17408
    ds_read_b64_tr_b16 a[92:93], v255 offset:6144
    v_mfma_f32_16x16x32_bf16 v[124:127], v[28:31], v[208:211], v[124:127]
    ds_read_b64_tr_b16 a[94:95], v255 offset:6912
    s_waitcnt lgkmcnt(15)
    v_mfma_f32_16x16x32_bf16 v[104:107], v[32:35], v[184:187], v[104:107]
    ds_read_b128 v[28:31], v1 offset:16
    s_add_u32 s35, s46, 4096
    v_mfma_f32_16x16x32_bf16 v[128:131], v[32:35], v[208:211], v[128:131]
    ds_read_b64_tr_b16 a[96:97], v254 offset:12288
    s_waitcnt lgkmcnt(15)
    v_mfma_f32_16x16x32_bf16 v[84:87], v[36:39], v[188:191], v[84:87]
    ds_read_b128 v[32:35], v1 offset:1616
    ds_read_b64_tr_b16 a[98:99], v254 offset:13056
    buffer_load_dwordx4 v[144:147], v7, s[8:11], 0 offen
    v_mfma_f32_16x16x32_bf16 v[108:111], v[36:39], v[212:215], v[108:111]
    s_add_u32 m0, s33, 100224
    s_waitcnt lgkmcnt(15)
    v_mfma_f32_16x16x32_bf16 v[88:91], v[40:43], v[188:191], v[88:91]
    ds_read_b128 v[36:39], v1 offset:3216
    ds_read_b64_tr_b16 a[100:101], v254 offset:12296
    v_mfma_f32_16x16x32_bf16 v[112:115], v[40:43], v[212:215], v[112:115]
    ds_read_b64_tr_b16 a[102:103], v254 offset:13064
    s_waitcnt lgkmcnt(15)
    v_mfma_f32_16x16x32_bf16 v[92:95], v[44:47], v[188:191], v[92:95]
    ds_read_b128 v[40:43], v1 offset:272
    s_mov_b32 exec_hi, 0
    buffer_load_dwordx4 v13, s[16:19], s35 offen lds
    s_mov_b32 exec_hi, -1
    v_mfma_f32_16x16x32_bf16 v[116:119], v[44:47], v[212:215], v[116:119]
    ds_read_b64_tr_b16 a[104:105], v255 offset:12288
    s_waitcnt lgkmcnt(15)
    v_mfma_f32_16x16x32_bf16 v[96:99], v[16:19], v[188:191], v[96:99]
    ds_read_b128 v[44:47], v1 offset:1872
    ds_read_b64_tr_b16 a[106:107], v255 offset:13056
    v_mfma_f32_16x16x32_bf16 v[120:123], v[16:19], v[212:215], v[120:123]
    buffer_load_dwordx4 v[148:151], v7, s[8:11], 0 offen offset:64
    s_waitcnt lgkmcnt(15)
    v_mfma_f32_16x16x32_bf16 v[100:103], v[20:23], v[188:191], v[100:103]
    ds_read_b128 v[16:19], v1 offset:3472
    v_mfma_f32_16x16x32_bf16 v[124:127], v[20:23], v[212:215], v[124:127]
    s_waitcnt lgkmcnt(14)
    v_mfma_f32_16x16x32_bf16 v[104:107], v[24:27], v[188:191], v[104:107]
    ds_read_b128 v[20:23], v1 offset:528
    v_mfma_f32_16x16x32_bf16 v[128:131], v[24:27], v[212:215], v[128:131]
    s_waitcnt lgkmcnt(12)
    v_mfma_f32_16x16x32_bf16 v[48:51], a[36:39], v[28:31], v[48:51]
    ds_read_b128 v[24:27], v1 offset:2128
    v_mfma_f32_16x16x32_bf16 v[52:55], a[40:43], v[28:31], v[52:55]
    v_mfma_f32_16x16x32_bf16 v[56:59], a[44:47], v[28:31], v[56:59]
    s_waitcnt lgkmcnt(11)
    v_mfma_f32_16x16x32_bf16 v[48:51], a[48:51], v[32:35], v[48:51]
    ds_read_b128 v[28:31], v1 offset:3728
    buffer_load_dwordx4 v[152:155], v7, s[8:11], 0 offen offset:128
    v_cvt_pk_bf16_f32 v84, v84, v85
    v_cvt_pk_bf16_f32 v85, v86, v87
    v_mfma_f32_16x16x32_bf16 v[52:55], a[52:55], v[32:35], v[52:55]
    v_cvt_pk_bf16_f32 v86, v88, v89
    v_cvt_pk_bf16_f32 v87, v90, v91
    v_mfma_f32_16x16x32_bf16 v[56:59], a[56:59], v[32:35], v[56:59]
    ds_write_b128 v9, v[84:87] offset:0
    v_cvt_pk_bf16_f32 v92, v92, v93
    s_waitcnt lgkmcnt(11)
    v_mfma_f32_16x16x32_bf16 v[48:51], a[60:63], v[36:39], v[48:51]
    ds_read_b128 v[32:35], v1 offset:32
    v_cvt_pk_bf16_f32 v93, v94, v95
    v_cvt_pk_bf16_f32 v94, v96, v97
    v_mfma_f32_16x16x32_bf16 v[52:55], a[64:67], v[36:39], v[52:55]
    v_cvt_pk_bf16_f32 v95, v98, v99
    ds_write_b128 v9, v[92:95] offset:1600
    v_mfma_f32_16x16x32_bf16 v[56:59], a[68:71], v[36:39], v[56:59]
    v_cvt_pk_bf16_f32 v100, v100, v101
    v_cvt_pk_bf16_f32 v101, v102, v103
    s_waitcnt lgkmcnt(10)
    v_mfma_f32_16x16x32_bf16 v[60:63], a[36:39], v[40:43], v[60:63]
    ds_read_b128 v[36:39], v1 offset:1632
    v_cvt_pk_bf16_f32 v102, v104, v105
    v_cvt_pk_bf16_f32 v103, v106, v107
    v_mfma_f32_16x16x32_bf16 v[64:67], a[40:43], v[40:43], v[64:67]
    ds_write_b128 v9, v[100:103] offset:3200
    v_add_u32 v9, v9, v11
    v_mfma_f32_16x16x32_bf16 v[68:71], a[44:47], v[40:43], v[68:71]
    v_add_u32 v5, 0x24000, v5
    v_cvt_pk_bf16_f32 v108, v108, v109
    s_waitcnt lgkmcnt(10)
    v_mfma_f32_16x16x32_bf16 v[60:63], a[48:51], v[44:47], v[60:63]
    ds_read_b128 v[40:43], v1 offset:3232
    v_cvt_pk_bf16_f32 v109, v110, v111
    v_cvt_pk_bf16_f32 v110, v112, v113
    v_mfma_f32_16x16x32_bf16 v[64:67], a[52:55], v[44:47], v[64:67]
    v_cvt_pk_bf16_f32 v111, v114, v115
    ds_write_b128 v10, v[108:111] offset:0
    v_mfma_f32_16x16x32_bf16 v[68:71], a[56:59], v[44:47], v[68:71]
    v_cvt_pk_bf16_f32 v116, v116, v117
    v_cvt_pk_bf16_f32 v117, v118, v119
    s_waitcnt lgkmcnt(10)
    v_mfma_f32_16x16x32_bf16 v[60:63], a[60:63], v[16:19], v[60:63]
    ds_read_b128 v[44:47], v1 offset:288
    v_cvt_pk_bf16_f32 v118, v120, v121
    v_cvt_pk_bf16_f32 v119, v122, v123
    v_mfma_f32_16x16x32_bf16 v[64:67], a[64:67], v[16:19], v[64:67]
    ds_write_b128 v10, v[116:119] offset:1600
    v_cvt_pk_bf16_f32 v124, v124, v125
    v_mfma_f32_16x16x32_bf16 v[68:71], a[68:71], v[16:19], v[68:71]
    v_cvt_pk_bf16_f32 v125, v126, v127
    v_cvt_pk_bf16_f32 v126, v128, v129
    s_waitcnt lgkmcnt(11)
    v_mfma_f32_16x16x32_bf16 v[72:75], a[36:39], v[20:23], v[72:75]
    ds_read_b128 v[16:19], v1 offset:1888
    v_add_u32 v7, 0x9000, v7
    v_cvt_pk_bf16_f32 v127, v130, v131
    ds_write_b128 v10, v[124:127] offset:3200
    v_mfma_f32_16x16x32_bf16 v[76:79], a[40:43], v[20:23], v[76:79]
    v_add_u32 v10, v10, v12
    v_mfma_f32_16x16x32_bf16 v[80:83], a[44:47], v[20:23], v[80:83]
    s_waitcnt lgkmcnt(12)
    v_mfma_f32_16x16x32_bf16 v[72:75], a[48:51], v[24:27], v[72:75]
    ds_read_b128 v[20:23], v1 offset:3488
    s_waitcnt vmcnt(16) lgkmcnt(1)
    s_barrier
    v_add_u32 v254, 28800, v14
    v_mfma_f32_16x16x32_bf16 v[76:79], a[52:55], v[24:27], v[76:79]
    v_add_u32 v255, 28800, v15
    v_mfma_f32_16x16x32_bf16 v[80:83], a[56:59], v[24:27], v[80:83]
    s_add_u32 s46, s33, 110592
    v_mfma_f32_16x16x32_bf16 v[72:75], a[60:63], v[28:31], v[72:75]
    ds_read_b128 v[24:27], v1 offset:544
    ds_read_b64_tr_b16 a[108:109], v254 offset:0
    v_mfma_f32_16x16x32_bf16 v[76:79], a[64:67], v[28:31], v[76:79]
    ds_read_b64_tr_b16 a[110:111], v254 offset:768
    v_mfma_f32_16x16x32_bf16 v[80:83], a[68:71], v[28:31], v[80:83]
    buffer_load_dwordx4 v[156:159], v6, s[4:7], 0 offen
    s_add_u32 m0, s33, 114560
    v_mfma_f32_16x16x32_bf16 v[48:51], a[72:75], v[32:35], v[48:51]
    ds_read_b128 v[28:31], v1 offset:2144
    ds_read_b64_tr_b16 a[112:113], v254 offset:8
    v_mfma_f32_16x16x32_bf16 v[52:55], a[76:79], v[32:35], v[52:55]
    ds_read_b64_tr_b16 a[114:115], v254 offset:776
    v_mfma_f32_16x16x32_bf16 v[56:59], a[80:83], v[32:35], v[56:59]
    buffer_load_dwordx4 v13, s[16:19], s46 offen lds
    v_mfma_f32_16x16x32_bf16 v[48:51], a[84:87], v[36:39], v[48:51]
    ds_read_b128 v[32:35], v1 offset:3744
    ds_read_b64_tr_b16 a[116:117], v255 offset:0
    v_mfma_f32_16x16x32_bf16 v[52:55], a[88:91], v[36:39], v[52:55]
    ds_read_b64_tr_b16 a[118:119], v255 offset:768
    v_mfma_f32_16x16x32_bf16 v[56:59], a[92:95], v[36:39], v[56:59]
    buffer_load_dwordx4 v13, s[16:19], s46 offen offset:1024 lds
    v_mfma_f32_16x16x32_bf16 v[48:51], a[96:99], v[40:43], v[48:51]
    ds_read_b128 v[36:39], v1 offset:4800
    ds_read_b64_tr_b16 a[120:121], v254 offset:6144
    v_mfma_f32_16x16x32_bf16 v[52:55], a[100:103], v[40:43], v[52:55]
    buffer_load_dwordx4 v[160:163], v6, s[4:7], 0 offen offset:64
    ds_read_b64_tr_b16 a[122:123], v254 offset:6912
    v_mfma_f32_16x16x32_bf16 v[56:59], a[104:107], v[40:43], v[56:59]
    buffer_load_dwordx4 v13, s[16:19], s46 offen offset:2048 lds
    v_mfma_f32_16x16x32_bf16 v[60:63], a[72:75], v[44:47], v[60:63]
    ds_read_b128 v[40:43], v1 offset:6400
    ds_read_b64_tr_b16 a[124:125], v254 offset:6152
    v_mfma_f32_16x16x32_bf16 v[64:67], a[76:79], v[44:47], v[64:67]
    ds_read_b64_tr_b16 a[126:127], v254 offset:6920
    v_mfma_f32_16x16x32_bf16 v[68:71], a[80:83], v[44:47], v[68:71]
    buffer_load_dwordx4 v13, s[16:19], s46 offen offset:3072 lds
    v_mfma_f32_16x16x32_bf16 v[60:63], a[84:87], v[16:19], v[60:63]
    ds_read_b128 v[44:47], v1 offset:8000
    ds_read_b64_tr_b16 a[128:129], v255 offset:6144
    v_mfma_f32_16x16x32_bf16 v[64:67], a[88:91], v[16:19], v[64:67]
    ds_read_b64_tr_b16 a[130:131], v255 offset:6912
    v_mfma_f32_16x16x32_bf16 v[68:71], a[92:95], v[16:19], v[68:71]
    buffer_load_dwordx4 v[164:167], v6, s[4:7], 0 offen offset:128
    s_add_u32 s35, s46, 4096
    s_waitcnt lgkmcnt(15)
    v_mfma_f32_16x16x32_bf16 v[60:63], a[96:99], v[20:23], v[60:63]
    ds_read_b128 v[16:19], v1 offset:5056
    ds_read_b64_tr_b16 a[132:133], v254 offset:12288
    v_mfma_f32_16x16x32_bf16 v[64:67], a[100:103], v[20:23], v[64:67]
    ds_read_b64_tr_b16 a[134:135], v254 offset:13056
    v_mfma_f32_16x16x32_bf16 v[68:71], a[104:107], v[20:23], v[68:71]
    s_add_u32 m0, s33, 118656
    s_waitcnt lgkmcnt(15)
    v_mfma_f32_16x16x32_bf16 v[72:75], a[72:75], v[24:27], v[72:75]
    ds_read_b128 v[20:23], v1 offset:6656
    ds_read_b64_tr_b16 a[136:137], v254 offset:12296
    v_mfma_f32_16x16x32_bf16 v[76:79], a[76:79], v[24:27], v[76:79]
    ds_read_b64_tr_b16 a[138:139], v254 offset:13064
    v_mfma_f32_16x16x32_bf16 v[80:83], a[80:83], v[24:27], v[80:83]
    s_mov_b32 exec_hi, 0
    buffer_load_dwordx4 v13, s[16:19], s35 offen lds
    s_mov_b32 exec_hi, -1
    s_waitcnt lgkmcnt(15)
    v_mfma_f32_16x16x32_bf16 v[72:75], a[84:87], v[28:31], v[72:75]
    ds_read_b128 v[24:27], v1 offset:8256
    ds_read_b64_tr_b16 a[140:141], v255 offset:12288
    v_mfma_f32_16x16x32_bf16 v[76:79], a[88:91], v[28:31], v[76:79]
    buffer_load_dwordx4 v[168:171], v8, s[8:11], 0 offen
    ds_read_b64_tr_b16 a[142:143], v255 offset:13056
    v_mfma_f32_16x16x32_bf16 v[80:83], a[92:95], v[28:31], v[80:83]
    s_waitcnt lgkmcnt(15)
    v_mfma_f32_16x16x32_bf16 v[72:75], a[96:99], v[32:35], v[72:75]
    ds_read_b128 v[28:31], v1 offset:5312
    v_mfma_f32_16x16x32_bf16 v[76:79], a[100:103], v[32:35], v[76:79]
    v_mfma_f32_16x16x32_bf16 v[80:83], a[104:107], v[32:35], v[80:83]
    s_waitcnt vmcnt(20) lgkmcnt(1)
    s_barrier
    v_add_u32 v254, 47232, v14
    v_mfma_f32_16x16x32_bf16 v[48:51], a[108:111], v[36:39], v[48:51]
    ds_read_b128 v[32:35], v1 offset:6912
    v_add_u32 v255, 47232, v15
    v_mfma_f32_16x16x32_bf16 v[52:55], a[112:115], v[36:39], v[52:55]
    s_add_u32 s46, s33, 129024
    v_mfma_f32_16x16x32_bf16 v[56:59], a[116:119], v[36:39], v[56:59]
    ds_read_b64_tr_b16 a[144:145], v254 offset:0
    v_mfma_f32_16x16x32_bf16 v[48:51], a[120:123], v[40:43], v[48:51]
    ds_read_b128 v[36:39], v1 offset:8512
    buffer_load_dwordx4 v[172:175], v8, s[8:11], 0 offen offset:64
    ds_read_b64_tr_b16 a[146:147], v254 offset:768
    v_mfma_f32_16x16x32_bf16 v[52:55], a[124:127], v[40:43], v[52:55]
    s_add_u32 m0, s33, 28800
    v_mfma_f32_16x16x32_bf16 v[56:59], a[128:131], v[40:43], v[56:59]
    ds_read_b64_tr_b16 a[148:149], v254 offset:8
    ds_read_b64_tr_b16 a[150:151], v254 offset:776
    v_mfma_f32_16x16x32_bf16 v[48:51], a[132:135], v[44:47], v[48:51]
    ds_read_b128 v[40:43], v1 offset:4816
    buffer_load_dwordx4 v13, s[16:19], s46 offen lds
    v_mfma_f32_16x16x32_bf16 v[52:55], a[136:139], v[44:47], v[52:55]
    ds_read_b64_tr_b16 a[152:153], v255 offset:0
    v_mfma_f32_16x16x32_bf16 v[56:59], a[140:143], v[44:47], v[56:59]
    ds_read_b64_tr_b16 a[154:155], v255 offset:768
    v_mfma_f32_16x16x32_bf16 v[60:63], a[108:111], v[16:19], v[60:63]
    ds_read_b128 v[44:47], v1 offset:6416
    buffer_load_dwordx4 v13, s[16:19], s46 offen offset:1024 lds
    v_mfma_f32_16x16x32_bf16 v[64:67], a[112:115], v[16:19], v[64:67]
    buffer_load_dwordx4 v[176:179], v8, s[8:11], 0 offen offset:128
    ds_read_b64_tr_b16 a[156:157], v254 offset:6144
    v_mfma_f32_16x16x32_bf16 v[68:71], a[116:119], v[16:19], v[68:71]
    ds_read_b64_tr_b16 a[158:159], v254 offset:6912
    v_mfma_f32_16x16x32_bf16 v[60:63], a[120:123], v[20:23], v[60:63]
    ds_read_b128 v[16:19], v1 offset:8016
    buffer_load_dwordx4 v13, s[16:19], s46 offen offset:2048 lds
    ds_read_b64_tr_b16 a[160:161], v254 offset:6152
    v_mfma_f32_16x16x32_bf16 v[64:67], a[124:127], v[20:23], v[64:67]
    ds_read_b64_tr_b16 a[162:163], v254 offset:6920
    v_mfma_f32_16x16x32_bf16 v[68:71], a[128:131], v[20:23], v[68:71]
    buffer_load_dwordx4 v13, s[16:19], s46 offen offset:3072 lds
    v_mfma_f32_16x16x32_bf16 v[60:63], a[132:135], v[24:27], v[60:63]
    ds_read_b128 v[20:23], v1 offset:5072
    ds_read_b64_tr_b16 a[164:165], v255 offset:6144
    v_mfma_f32_16x16x32_bf16 v[64:67], a[136:139], v[24:27], v[64:67]
    ds_read_b64_tr_b16 a[166:167], v255 offset:6912
    v_mfma_f32_16x16x32_bf16 v[68:71], a[140:143], v[24:27], v[68:71]
    s_add_u32 s35, s46, 4096
    s_waitcnt lgkmcnt(15)
    v_mfma_f32_16x16x32_bf16 v[72:75], a[108:111], v[28:31], v[72:75]
    ds_read_b128 v[24:27], v1 offset:6672
    v_add_u32 v6, 0x24000, v6
    ds_read_b64_tr_b16 a[168:169], v254 offset:12288
    ds_read_b64_tr_b16 a[170:171], v254 offset:13056
    v_mfma_f32_16x16x32_bf16 v[76:79], a[112:115], v[28:31], v[76:79]
    s_add_u32 m0, s33, 32896
    v_mfma_f32_16x16x32_bf16 v[80:83], a[116:119], v[28:31], v[80:83]
    ds_read_b64_tr_b16 a[172:173], v254 offset:12296
    s_waitcnt lgkmcnt(15)
    v_mfma_f32_16x16x32_bf16 v[72:75], a[120:123], v[32:35], v[72:75]
    ds_read_b128 v[28:31], v1 offset:8272
    ds_read_b64_tr_b16 a[174:175], v254 offset:13064
    v_mfma_f32_16x16x32_bf16 v[76:79], a[124:127], v[32:35], v[76:79]
    s_mov_b32 exec_hi, 0
    buffer_load_dwordx4 v13, s[16:19], s35 offen lds
    s_mov_b32 exec_hi, -1
    v_mfma_f32_16x16x32_bf16 v[80:83], a[128:131], v[32:35], v[80:83]
    ds_read_b64_tr_b16 a[176:177], v255 offset:12288
    s_waitcnt lgkmcnt(15)
    v_mfma_f32_16x16x32_bf16 v[72:75], a[132:135], v[36:39], v[72:75]
    ds_read_b128 v[32:35], v1 offset:5328
    ds_read_b64_tr_b16 a[178:179], v255 offset:13056
    v_mfma_f32_16x16x32_bf16 v[76:79], a[136:139], v[36:39], v[76:79]
    v_mfma_f32_16x16x32_bf16 v[80:83], a[140:143], v[36:39], v[80:83]
    v_add_u32 v8, 0x9000, v8
    s_waitcnt vmcnt(18) lgkmcnt(0)
    s_barrier
    v_add_u32 v254, 96128, v14
    v_mfma_f32_16x16x32_bf16 v[48:51], a[144:147], v[40:43], v[48:51]
    ds_read_b128 v[36:39], v1 offset:6928
    v_add_u32 v255, 96128, v15
    v_mfma_f32_16x16x32_bf16 v[52:55], a[148:151], v[40:43], v[52:55]
    s_add_u32 s46, s33, 147456
    v_mfma_f32_16x16x32_bf16 v[56:59], a[152:155], v[40:43], v[56:59]
    ds_read_b64_tr_b16 a[180:181], v254 offset:0
    v_mfma_f32_16x16x32_bf16 v[48:51], a[156:159], v[44:47], v[48:51]
    ds_read_b128 v[40:43], v1 offset:8528
    ds_read_b64_tr_b16 a[182:183], v254 offset:768
    v_mfma_f32_16x16x32_bf16 v[52:55], a[160:163], v[44:47], v[52:55]
    s_add_u32 m0, s33, 47232
    v_mfma_f32_16x16x32_bf16 v[56:59], a[164:167], v[44:47], v[56:59]
    ds_read_b64_tr_b16 a[184:185], v254 offset:8
    ds_read_b64_tr_b16 a[186:187], v254 offset:776
    v_mfma_f32_16x16x32_bf16 v[48:51], a[168:171], v[16:19], v[48:51]
    ds_read_b128 v[44:47], v1 offset:4832
    buffer_load_dwordx4 v13, s[16:19], s46 offen lds
    v_mfma_f32_16x16x32_bf16 v[52:55], a[172:175], v[16:19], v[52:55]
    ds_read_b64_tr_b16 a[188:189], v255 offset:0
    v_mfma_f32_16x16x32_bf16 v[56:59], a[176:179], v[16:19], v[56:59]
    ds_read_b64_tr_b16 a[190:191], v255 offset:768
    v_lshlrev_b32 v84, 16, v144
    v_and_b32 v85, 0xffff0000, v144
    v_mfma_f32_16x16x32_bf16 v[60:63], a[144:147], v[20:23], v[60:63]
    ds_read_b128 v[16:19], v1 offset:6432
    buffer_load_dwordx4 v13, s[16:19], s46 offen offset:1024 lds
    v_lshlrev_b32 v86, 16, v145
    v_mfma_f32_16x16x32_bf16 v[64:67], a[148:151], v[20:23], v[64:67]
    ds_read_b64_tr_b16 a[192:193], v254 offset:6144
    v_and_b32 v87, 0xffff0000, v145
    v_mfma_f32_16x16x32_bf16 v[68:71], a[152:155], v[20:23], v[68:71]
    ds_read_b64_tr_b16 a[194:195], v254 offset:6912
    v_lshlrev_b32 v88, 16, v146
    v_mfma_f32_16x16x32_bf16 v[60:63], a[156:159], v[24:27], v[60:63]
    ds_read_b128 v[20:23], v1 offset:8032
    buffer_load_dwordx4 v13, s[16:19], s46 offen offset:2048 lds
    ds_read_b64_tr_b16 a[196:197], v254 offset:6152
    v_and_b32 v89, 0xffff0000, v146
    v_mfma_f32_16x16x32_bf16 v[64:67], a[160:163], v[24:27], v[64:67]
    ds_read_b64_tr_b16 a[198:199], v254 offset:6920
    v_lshlrev_b32 v90, 16, v147
    v_mfma_f32_16x16x32_bf16 v[68:71], a[164:167], v[24:27], v[68:71]
    buffer_load_dwordx4 v13, s[16:19], s46 offen offset:3072 lds
    v_and_b32 v91, 0xffff0000, v147
    v_mfma_f32_16x16x32_bf16 v[60:63], a[168:171], v[28:31], v[60:63]
    ds_read_b128 v[24:27], v1 offset:5088
    ds_read_b64_tr_b16 a[200:201], v255 offset:6144
    s_waitcnt vmcnt(21)
    v_lshlrev_b32 v92, 16, v148
    v_mfma_f32_16x16x32_bf16 v[64:67], a[172:175], v[28:31], v[64:67]
    ds_read_b64_tr_b16 a[202:203], v255 offset:6912
    v_and_b32 v93, 0xffff0000, v148
    v_mfma_f32_16x16x32_bf16 v[68:71], a[176:179], v[28:31], v[68:71]
    s_add_u32 s35, s46, 4096
    v_lshlrev_b32 v94, 16, v149
    v_mfma_f32_16x16x32_bf16 v[72:75], a[144:147], v[32:35], v[72:75]
    ds_read_b128 v[28:31], v1 offset:6688
    ds_read_b64_tr_b16 a[204:205], v254 offset:12288
    ds_read_b64_tr_b16 a[206:207], v254 offset:13056
    v_and_b32 v95, 0xffff0000, v149
    v_mfma_f32_16x16x32_bf16 v[76:79], a[148:151], v[32:35], v[76:79]
    s_add_u32 m0, s33, 51328
    v_lshlrev_b32 v96, 16, v150
    v_and_b32 v97, 0xffff0000, v150
    v_mfma_f32_16x16x32_bf16 v[80:83], a[152:155], v[32:35], v[80:83]
    ds_read_b64_tr_b16 a[208:209], v254 offset:12296
    v_lshlrev_b32 v98, 16, v151
    s_waitcnt lgkmcnt(15)
    v_mfma_f32_16x16x32_bf16 v[72:75], a[156:159], v[36:39], v[72:75]
    ds_read_b128 v[32:35], v1 offset:8288
    ds_read_b64_tr_b16 a[210:211], v254 offset:13064
    v_and_b32 v99, 0xffff0000, v151
    v_mfma_f32_16x16x32_bf16 v[76:79], a[160:163], v[36:39], v[76:79]
    s_mov_b32 exec_hi, 0
    buffer_load_dwordx4 v13, s[16:19], s35 offen lds
    s_mov_b32 exec_hi, -1
    s_waitcnt vmcnt(21)
    v_lshlrev_b32 v100, 16, v152
    v_mfma_f32_16x16x32_bf16 v[80:83], a[164:167], v[36:39], v[80:83]
    ds_read_b64_tr_b16 a[212:213], v255 offset:12288
    v_and_b32 v101, 0xffff0000, v152
    s_waitcnt lgkmcnt(15)
    v_mfma_f32_16x16x32_bf16 v[72:75], a[168:171], v[40:43], v[72:75]
    ds_read_b128 v[36:39], v1 offset:5344
    ds_read_b64_tr_b16 a[214:215], v255 offset:13056
    v_lshlrev_b32 v102, 16, v153
    v_mfma_f32_16x16x32_bf16 v[76:79], a[172:175], v[40:43], v[76:79]
    v_and_b32 v103, 0xffff0000, v153
    v_mfma_f32_16x16x32_bf16 v[80:83], a[176:179], v[40:43], v[80:83]
    v_lshlrev_b32 v104, 16, v154
    s_waitcnt lgkmcnt(15)
    v_mfma_f32_16x16x32_bf16 v[48:51], a[180:183], v[44:47], v[48:51]
    ds_read_b128 v[40:43], v1 offset:6944
    v_and_b32 v105, 0xffff0000, v154
    v_mfma_f32_16x16x32_bf16 v[52:55], a[184:187], v[44:47], v[52:55]
    v_lshlrev_b32 v106, 16, v155
    s_waitcnt vmcnt(13) lgkmcnt(1)
    s_barrier
    v_mfma_f32_16x16x32_bf16 v[56:59], a[188:191], v[44:47], v[56:59]
    v_and_b32 v107, 0xffff0000, v155
    v_add_u32 v254, 114560, v14
    v_mfma_f32_16x16x32_bf16 v[48:51], a[192:195], v[16:19], v[48:51]
    ds_read_b128 v[44:47], v1 offset:8544
    s_waitcnt vmcnt(12)
    v_lshlrev_b32 v108, 16, v168
    v_and_b32 v109, 0xffff0000, v168
    v_add_u32 v255, 114560, v15
    v_mfma_f32_16x16x32_bf16 v[52:55], a[196:199], v[16:19], v[52:55]
    v_lshlrev_b32 v110, 16, v169
    v_mfma_f32_16x16x32_bf16 v[56:59], a[200:203], v[16:19], v[56:59]
    v_and_b32 v111, 0xffff0000, v169
    ds_read_b64_tr_b16 a[216:217], v254 offset:0
    v_mfma_f32_16x16x32_bf16 v[48:51], a[204:207], v[20:23], v[48:51]
    ds_read_b128 v[16:19], v2 offset:0
    v_lshlrev_b32 v112, 16, v170
    ds_read_b64_tr_b16 a[218:219], v254 offset:768
    v_mfma_f32_16x16x32_bf16 v[52:55], a[208:211], v[20:23], v[52:55]
    v_and_b32 v113, 0xffff0000, v170
    ds_read_b64_tr_b16 a[220:221], v254 offset:8
    v_mfma_f32_16x16x32_bf16 v[56:59], a[212:215], v[20:23], v[56:59]
    v_lshlrev_b32 v114, 16, v171
    v_mfma_f32_16x16x32_bf16 v[60:63], a[180:183], v[24:27], v[60:63]
    ds_read_b128 v[20:23], v2 offset:3072
    v_and_b32 v115, 0xffff0000, v171
    ds_read_b64_tr_b16 a[222:223], v254 offset:776
    v_mfma_f32_16x16x32_bf16 v[64:67], a[184:187], v[24:27], v[64:67]
    s_waitcnt vmcnt(11)
    v_lshlrev_b32 v116, 16, v172
    ds_read_b64_tr_b16 a[224:225], v255 offset:0
    v_mfma_f32_16x16x32_bf16 v[68:71], a[188:191], v[24:27], v[68:71]
    v_and_b32 v117, 0xffff0000, v172
    v_mfma_f32_16x16x32_bf16 v[60:63], a[192:195], v[28:31], v[60:63]
    ds_read_b128 v[24:27], v2 offset:6144
    v_lshlrev_b32 v118, 16, v173
    ds_read_b64_tr_b16 a[226:227], v255 offset:768
    v_mfma_f32_16x16x32_bf16 v[64:67], a[196:199], v[28:31], v[64:67]
    v_and_b32 v119, 0xffff0000, v173
    ds_read_b64_tr_b16 a[228:229], v254 offset:6144
    v_mfma_f32_16x16x32_bf16 v[68:71], a[200:203], v[28:31], v[68:71]
    v_lshlrev_b32 v120, 16, v174
    v_and_b32 v121, 0xffff0000, v174
    ds_read_b64_tr_b16 a[230:231], v254 offset:6912
    v_mfma_f32_16x16x32_bf16 v[60:63], a[204:207], v[32:35], v[60:63]
    ds_read_b128 v[28:31], v2 offset:9216
    v_lshlrev_b32 v122, 16, v175
    v_mfma_f32_16x16x32_bf16 v[64:67], a[208:211], v[32:35], v[64:67]
    v_and_b32 v123, 0xffff0000, v175
    ds_read_b64_tr_b16 a[232:233], v254 offset:6152
    v_mfma_f32_16x16x32_bf16 v[68:71], a[212:215], v[32:35], v[68:71]
    s_waitcnt vmcnt(8)
    v_lshlrev_b32 v124, 16, v176
    ds_read_b64_tr_b16 a[234:235], v254 offset:6920
    v_mfma_f32_16x16x32_bf16 v[72:75], a[180:183], v[36:39], v[72:75]
    ds_read_b128 v[32:35], v2 offset:12288
    v_and_b32 v125, 0xffff0000, v176
    ds_read_b64_tr_b16 a[236:237], v255 offset:6144
    v_mfma_f32_16x16x32_bf16 v[76:79], a[184:187], v[36:39], v[76:79]
    v_lshlrev_b32 v126, 16, v177
    v_mfma_f32_16x16x32_bf16 v[80:83], a[188:191], v[36:39], v[80:83]
    v_and_b32 v127, 0xffff0000, v177
    ds_read_b64_tr_b16 a[238:239], v255 offset:6912
    s_waitcnt lgkmcnt(15)
    v_mfma_f32_16x16x32_bf16 v[72:75], a[192:195], v[40:43], v[72:75]
    ds_read_b128 v[36:39], v2 offset:15360
    v_lshlrev_b32 v128, 16, v178
    ds_read_b64_tr_b16 a[240:241], v254 offset:12288
    v_mfma_f32_16x16x32_bf16 v[76:79], a[196:199], v[40:43], v[76:79]
    v_and_b32 v129, 0xffff0000, v178
    v_mfma_f32_16x16x32_bf16 v[80:83], a[200:203], v[40:43], v[80:83]
    v_lshlrev_b32 v130, 16, v179
    ds_read_b64_tr_b16 a[242:243], v254 offset:13056
    s_waitcnt lgkmcnt(15)
    v_mfma_f32_16x16x32_bf16 v[72:75], a[204:207], v[44:47], v[72:75]
    ds_read_b128 v[40:43], v2 offset:1024
    v_and_b32 v131, 0xffff0000, v179
    ds_read_b64_tr_b16 a[244:245], v254 offset:12296
    v_mfma_f32_16x16x32_bf16 v[76:79], a[208:211], v[44:47], v[76:79]
    ds_read_b64_tr_b16 a[246:247], v254 offset:13064
    v_mfma_f32_16x16x32_bf16 v[80:83], a[212:215], v[44:47], v[80:83]
    s_waitcnt lgkmcnt(15)
    v_mfma_f32_16x16x32_bf16 v[84:87], v[16:19], v[132:135], v[84:87]
    ds_read_b128 v[44:47], v2 offset:4096
    ds_read_b64_tr_b16 a[248:249], v255 offset:12288
    v_mfma_f32_16x16x32_bf16 v[108:111], v[16:19], v[156:159], v[108:111]
    ds_read_b64_tr_b16 a[250:251], v255 offset:13056
    s_waitcnt lgkmcnt(15)
    v_mfma_f32_16x16x32_bf16 v[88:91], v[20:23], v[132:135], v[88:91]
    ds_read_b128 v[16:19], v2 offset:7168
    v_mfma_f32_16x16x32_bf16 v[112:115], v[20:23], v[156:159], v[112:115]
    s_waitcnt lgkmcnt(15)
    v_mfma_f32_16x16x32_bf16 v[92:95], v[24:27], v[132:135], v[92:95]
    ds_read_b128 v[20:23], v2 offset:10240
    v_mfma_f32_16x16x32_bf16 v[116:119], v[24:27], v[156:159], v[116:119]
    s_waitcnt lgkmcnt(15)
    v_mfma_f32_16x16x32_bf16 v[96:99], v[28:31], v[132:135], v[96:99]
    ds_read_b128 v[24:27], v2 offset:13312
    s_waitcnt vmcnt(5) lgkmcnt(3)
    s_barrier
    v_mfma_f32_16x16x32_bf16 v[120:123], v[28:31], v[156:159], v[120:123]
    v_add_u32 v254, 28800, v14
    v_mfma_f32_16x16x32_bf16 v[100:103], v[32:35], v[132:135], v[100:103]
    ds_read_b128 v[28:31], v2 offset:16384
    v_add_u32 v255, 28800, v15
    v_mfma_f32_16x16x32_bf16 v[124:127], v[32:35], v[156:159], v[124:127]
    v_mfma_f32_16x16x32_bf16 v[104:107], v[36:39], v[132:135], v[104:107]
    ds_read_b128 v[32:35], v2 offset:2048
    ds_read_b64_tr_b16 a[252:253], v254 offset:0
    v_mfma_f32_16x16x32_bf16 v[128:131], v[36:39], v[156:159], v[128:131]
    ds_read_b64_tr_b16 a[254:255], v254 offset:768
    v_mfma_f32_16x16x32_bf16 v[84:87], v[40:43], v[136:139], v[84:87]
    ds_read_b128 v[36:39], v2 offset:5120
    ds_read_b64_tr_b16 v[180:181], v254 offset:8
    v_mfma_f32_16x16x32_bf16 v[108:111], v[40:43], v[160:163], v[108:111]
    v_mfma_f32_16x16x32_bf16 v[88:91], v[44:47], v[136:139], v[88:91]
    ds_read_b128 v[40:43], v2 offset:8192
    ds_read_b64_tr_b16 v[182:183], v254 offset:776
    v_mfma_f32_16x16x32_bf16 v[112:115], v[44:47], v[160:163], v[112:115]
    ds_read_b64_tr_b16 v[184:185], v255 offset:0
    s_waitcnt lgkmcnt(11)
    v_mfma_f32_16x16x32_bf16 v[92:95], v[16:19], v[136:139], v[92:95]
    ds_read_b128 v[44:47], v2 offset:11264
    v_mfma_f32_16x16x32_bf16 v[116:119], v[16:19], v[160:163], v[116:119]
    ds_read_b64_tr_b16 v[186:187], v255 offset:768
    s_waitcnt lgkmcnt(12)
    v_mfma_f32_16x16x32_bf16 v[96:99], v[20:23], v[136:139], v[96:99]
    ds_read_b128 v[16:19], v2 offset:14336
    ds_read_b64_tr_b16 v[188:189], v254 offset:6144
    v_mfma_f32_16x16x32_bf16 v[120:123], v[20:23], v[160:163], v[120:123]
    ds_read_b64_tr_b16 v[190:191], v254 offset:6912
    s_waitcnt lgkmcnt(14)
    v_mfma_f32_16x16x32_bf16 v[100:103], v[24:27], v[136:139], v[100:103]
    ds_read_b128 v[20:23], v2 offset:17408
    v_mfma_f32_16x16x32_bf16 v[124:127], v[24:27], v[160:163], v[124:127]
    ds_read_b64_tr_b16 v[192:193], v254 offset:6152
    s_waitcnt lgkmcnt(15)
    v_mfma_f32_16x16x32_bf16 v[104:107], v[28:31], v[136:139], v[104:107]
    ds_read_b128 v[24:27], v1 offset:9600
    ds_read_b64_tr_b16 v[194:195], v254 offset:6920
    v_mfma_f32_16x16x32_bf16 v[128:131], v[28:31], v[160:163], v[128:131]
    ds_read_b64_tr_b16 v[196:197], v255 offset:6144
    s_waitcnt lgkmcnt(15)
    v_mfma_f32_16x16x32_bf16 v[84:87], v[32:35], v[140:143], v[84:87]
    ds_read_b128 v[28:31], v1 offset:11200
    v_mfma_f32_16x16x32_bf16 v[108:111], v[32:35], v[164:167], v[108:111]
    ds_read_b64_tr_b16 v[198:199], v255 offset:6912
    s_waitcnt lgkmcnt(15)
    v_mfma_f32_16x16x32_bf16 v[88:91], v[36:39], v[140:143], v[88:91]
    ds_read_b128 v[32:35], v1 offset:12800
    ds_read_b64_tr_b16 v[200:201], v254 offset:12288
    v_mfma_f32_16x16x32_bf16 v[112:115], v[36:39], v[164:167], v[112:115]
    s_waitcnt lgkmcnt(15)
    v_mfma_f32_16x16x32_bf16 v[92:95], v[40:43], v[140:143], v[92:95]
    ds_read_b128 v[36:39], v1 offset:9856
    ds_read_b64_tr_b16 v[202:203], v254 offset:13056
    v_mfma_f32_16x16x32_bf16 v[116:119], v[40:43], v[164:167], v[116:119]
    ds_read_b64_tr_b16 v[204:205], v254 offset:12296
    s_waitcnt lgkmcnt(15)
    v_mfma_f32_16x16x32_bf16 v[96:99], v[44:47], v[140:143], v[96:99]
    ds_read_b128 v[40:43], v1 offset:11456
    ds_read_b64_tr_b16 v[206:207], v254 offset:13064
    v_mfma_f32_16x16x32_bf16 v[120:123], v[44:47], v[164:167], v[120:123]
    s_waitcnt lgkmcnt(15)
    v_mfma_f32_16x16x32_bf16 v[100:103], v[16:19], v[140:143], v[100:103]
    ds_read_b128 v[44:47], v1 offset:13056
    ds_read_b64_tr_b16 v[208:209], v255 offset:12288
    v_mfma_f32_16x16x32_bf16 v[124:127], v[16:19], v[164:167], v[124:127]
    ds_read_b64_tr_b16 v[210:211], v255 offset:13056
    s_waitcnt lgkmcnt(15)
    v_mfma_f32_16x16x32_bf16 v[104:107], v[20:23], v[140:143], v[104:107]
    ds_read_b128 v[16:19], v1 offset:10112
    v_mfma_f32_16x16x32_bf16 v[128:131], v[20:23], v[164:167], v[128:131]
    s_waitcnt lgkmcnt(15)
    v_mfma_f32_16x16x32_bf16 v[48:51], a[216:219], v[24:27], v[48:51]
    ds_read_b128 v[20:23], v1 offset:11712
    v_mfma_f32_16x16x32_bf16 v[52:55], a[220:223], v[24:27], v[52:55]
    v_mfma_f32_16x16x32_bf16 v[56:59], a[224:227], v[24:27], v[56:59]
    s_waitcnt vmcnt(0) lgkmcnt(2)
    s_barrier
    buffer_load_dwordx4 v[132:135], v5, s[4:7], 0 offen
    v_mfma_f32_16x16x32_bf16 v[48:51], a[228:231], v[28:31], v[48:51]
    ds_read_b128 v[24:27], v1 offset:13312
    v_add_u32 v254, 47232, v14
    v_mfma_f32_16x16x32_bf16 v[52:55], a[232:235], v[28:31], v[52:55]
    v_add_u32 v255, 47232, v15
    v_mfma_f32_16x16x32_bf16 v[56:59], a[236:239], v[28:31], v[56:59]
    ds_read_b64_tr_b16 v[212:213], v254 offset:0
    v_mfma_f32_16x16x32_bf16 v[48:51], a[240:243], v[32:35], v[48:51]
    ds_read_b128 v[28:31], v1 offset:9616
    buffer_load_dwordx4 v[136:139], v5, s[4:7], 0 offen offset:64
    v_mfma_f32_16x16x32_bf16 v[52:55], a[244:247], v[32:35], v[52:55]
    ds_read_b64_tr_b16 v[214:215], v254 offset:768
    v_mfma_f32_16x16x32_bf16 v[56:59], a[248:251], v[32:35], v[56:59]
    ds_read_b64_tr_b16 v[216:217], v254 offset:8
    v_mfma_f32_16x16x32_bf16 v[60:63], a[216:219], v[36:39], v[60:63]
    ds_read_b128 v[32:35], v1 offset:11216
    ds_read_b64_tr_b16 v[218:219], v254 offset:776
    v_mfma_f32_16x16x32_bf16 v[64:67], a[220:223], v[36:39], v[64:67]
    v_cvt_pk_bf16_f32 v84, v84, v85
    v_cvt_pk_bf16_f32 v85, v86, v87
    v_mfma_f32_16x16x32_bf16 v[68:71], a[224:227], v[36:39], v[68:71]
    ds_read_b64_tr_b16 v[220:221], v255 offset:0
    v_cvt_pk_bf16_f32 v86, v88, v89
    buffer_load_dwordx4 v[140:143], v5, s[4:7], 0 offen offset:128
    v_mfma_f32_16x16x32_bf16 v[60:63], a[228:231], v[40:43], v[60:63]
    ds_read_b128 v[36:39], v1 offset:12816
    ds_read_b64_tr_b16 v[222:223], v255 offset:768
    v_cvt_pk_bf16_f32 v87, v90, v91
    v_mfma_f32_16x16x32_bf16 v[64:67], a[232:235], v[40:43], v[64:67]
    ds_read_b64_tr_b16 v[224:225], v254 offset:6144
    ds_write_b128 v9, v[84:87] offset:0
    v_mfma_f32_16x16x32_bf16 v[68:71], a[236:239], v[40:43], v[68:71]
    ds_read_b64_tr_b16 v[226:227], v254 offset:6912
    v_cvt_pk_bf16_f32 v92, v92, v93
    v_mfma_f32_16x16x32_bf16 v[60:63], a[240:243], v[44:47], v[60:63]
    ds_read_b128 v[40:43], v1 offset:9872
    v_cvt_pk_bf16_f32 v93, v94, v95
    v_cvt_pk_bf16_f32 v94, v96, v97
    v_mfma_f32_16x16x32_bf16 v[64:67], a[244:247], v[44:47], v[64:67]
    ds_read_b64_tr_b16 v[228:229], v254 offset:6152
    v_cvt_pk_bf16_f32 v95, v98, v99
    buffer_load_dwordx4 v[144:147], v7, s[8:11], 0 offen
    v_mfma_f32_16x16x32_bf16 v[68:71], a[248:251], v[44:47], v[68:71]
    ds_read_b64_tr_b16 v[230:231], v254 offset:6920
    ds_write_b128 v9, v[92:95] offset:1600
    s_waitcnt lgkmcnt(15)
    v_mfma_f32_16x16x32_bf16 v[72:75], a[216:219], v[16:19], v[72:75]
    ds_read_b128 v[44:47], v1 offset:11472
    ds_read_b64_tr_b16 v[232:233], v255 offset:6144
    v_cvt_pk_bf16_f32 v100, v100, v101
    v_mfma_f32_16x16x32_bf16 v[76:79], a[220:223], v[16:19], v[76:79]
    v_cvt_pk_bf16_f32 v101, v102, v103
    v_mfma_f32_16x16x32_bf16 v[80:83], a[224:227], v[16:19], v[80:83]
    ds_read_b64_tr_b16 v[234:235], v255 offset:6912
    v_cvt_pk_bf16_f32 v102, v104, v105
    v_cvt_pk_bf16_f32 v103, v106, v107
    s_waitcnt lgkmcnt(15)
    v_mfma_f32_16x16x32_bf16 v[72:75], a[228:231], v[20:23], v[72:75]
    ds_read_b128 v[16:19], v1 offset:13072
    ds_read_b64_tr_b16 v[236:237], v254 offset:12288
    ds_write_b128 v9, v[100:103] offset:3200
    buffer_load_dwordx4 v[148:151], v7, s[8:11], 0 offen offset:64
    v_mfma_f32_16x16x32_bf16 v[76:79], a[232:235], v[20:23], v[76:79]
    ds_read_b64_tr_b16 v[238:239], v254 offset:13056
    v_add_u32 v9, v9, v11
    v_mfma_f32_16x16x32_bf16 v[80:83], a[236:239], v[20:23], v[80:83]
    ds_read_b64_tr_b16 v[240:241], v254 offset:12296
    v_cvt_pk_bf16_f32 v108, v108, v109
    s_waitcnt lgkmcnt(15)
    v_mfma_f32_16x16x32_bf16 v[72:75], a[240:243], v[24:27], v[72:75]
    ds_read_b128 v[20:23], v1 offset:10128
    v_cvt_pk_bf16_f32 v109, v110, v111
    v_mfma_f32_16x16x32_bf16 v[76:79], a[244:247], v[24:27], v[76:79]
    ds_read_b64_tr_b16 v[242:243], v254 offset:13064
    v_cvt_pk_bf16_f32 v110, v112, v113
    v_mfma_f32_16x16x32_bf16 v[80:83], a[248:251], v[24:27], v[80:83]
    ds_read_b64_tr_b16 v[244:245], v255 offset:12288
    v_cvt_pk_bf16_f32 v111, v114, v115
    ds_write_b128 v10, v[108:111] offset:0
    buffer_load_dwordx4 v[152:155], v7, s[8:11], 0 offen offset:128
    s_waitcnt lgkmcnt(15)
    v_mfma_f32_16x16x32_bf16 v[48:51], a[252:255], v[28:31], v[48:51]
    ds_read_b128 v[24:27], v1 offset:11728
    ds_read_b64_tr_b16 v[246:247], v255 offset:13056
    v_cvt_pk_bf16_f32 v116, v116, v117
    v_mfma_f32_16x16x32_bf16 v[52:55], v[180:183], v[28:31], v[52:55]
    v_cvt_pk_bf16_f32 v117, v118, v119
    v_mfma_f32_16x16x32_bf16 v[56:59], v[184:187], v[28:31], v[56:59]
    v_cvt_pk_bf16_f32 v118, v120, v121
    s_waitcnt lgkmcnt(15)
    v_mfma_f32_16x16x32_bf16 v[48:51], v[188:191], v[32:35], v[48:51]
    ds_read_b128 v[28:31], v1 offset:13328
    v_cvt_pk_bf16_f32 v119, v122, v123
    v_add_u32 v5, 0x24000, v5
    v_mfma_f32_16x16x32_bf16 v[52:55], v[192:195], v[32:35], v[52:55]
    ds_write_b128 v10, v[116:119] offset:1600
    v_cvt_pk_bf16_f32 v124, v124, v125
    v_mfma_f32_16x16x32_bf16 v[56:59], v[196:199], v[32:35], v[56:59]
    v_cvt_pk_bf16_f32 v125, v126, v127
    s_waitcnt lgkmcnt(15)
    v_mfma_f32_16x16x32_bf16 v[48:51], v[200:203], v[36:39], v[48:51]
    ds_read_b128 v[32:35], v1 offset:9632
    v_cvt_pk_bf16_f32 v126, v128, v129
    v_mfma_f32_16x16x32_bf16 v[52:55], v[204:207], v[36:39], v[52:55]
    v_cvt_pk_bf16_f32 v127, v130, v131
    v_mfma_f32_16x16x32_bf16 v[56:59], v[208:211], v[36:39], v[56:59]
    ds_write_b128 v10, v[124:127] offset:3200
    v_add_u32 v7, 0x9000, v7
    s_waitcnt lgkmcnt(15)
    v_mfma_f32_16x16x32_bf16 v[60:63], a[252:255], v[40:43], v[60:63]
    ds_read_b128 v[36:39], v1 offset:11232
    v_add_u32 v10, v10, v12
    v_mfma_f32_16x16x32_bf16 v[64:67], v[180:183], v[40:43], v[64:67]
    v_mfma_f32_16x16x32_bf16 v[68:71], v[184:187], v[40:43], v[68:71]
    s_waitcnt lgkmcnt(15)
    v_mfma_f32_16x16x32_bf16 v[60:63], v[188:191], v[44:47], v[60:63]
    ds_read_b128 v[40:43], v1 offset:12832
    v_mfma_f32_16x16x32_bf16 v[64:67], v[192:195], v[44:47], v[64:67]
    buffer_load_dwordx4 v[156:159], v6, s[4:7], 0 offen
    v_mfma_f32_16x16x32_bf16 v[68:71], v[196:199], v[44:47], v[68:71]
    s_waitcnt lgkmcnt(15)
    v_mfma_f32_16x16x32_bf16 v[60:63], v[200:203], v[16:19], v[60:63]
    ds_read_b128 v[44:47], v1 offset:9888
    v_mfma_f32_16x16x32_bf16 v[64:67], v[204:207], v[16:19], v[64:67]
    v_mfma_f32_16x16x32_bf16 v[68:71], v[208:211], v[16:19], v[68:71]
    s_waitcnt lgkmcnt(12)
    v_mfma_f32_16x16x32_bf16 v[72:75], a[252:255], v[20:23], v[72:75]
    ds_read_b128 v[16:19], v1 offset:11488
    buffer_load_dwordx4 v[160:163], v6, s[4:7], 0 offen offset:64
    v_mfma_f32_16x16x32_bf16 v[76:79], v[180:183], v[20:23], v[76:79]
    v_mfma_f32_16x16x32_bf16 v[80:83], v[184:187], v[20:23], v[80:83]
    s_waitcnt lgkmcnt(9)
    v_mfma_f32_16x16x32_bf16 v[72:75], v[188:191], v[24:27], v[72:75]
    ds_read_b128 v[20:23], v1 offset:13088
    v_mfma_f32_16x16x32_bf16 v[76:79], v[192:195], v[24:27], v[76:79]
    v_mfma_f32_16x16x32_bf16 v[80:83], v[196:199], v[24:27], v[80:83]
    buffer_load_dwordx4 v[164:167], v6, s[4:7], 0 offen offset:128
    s_waitcnt lgkmcnt(8)
    v_mfma_f32_16x16x32_bf16 v[72:75], v[200:203], v[28:31], v[72:75]
    ds_read_b128 v[24:27], v1 offset:10144
    v_mfma_f32_16x16x32_bf16 v[76:79], v[204:207], v[28:31], v[76:79]
    v_mfma_f32_16x16x32_bf16 v[80:83], v[208:211], v[28:31], v[80:83]
    s_waitcnt lgkmcnt(7)
    v_mfma_f32_16x16x32_bf16 v[48:51], v[212:215], v[32:35], v[48:51]
    ds_read_b128 v[28:31], v1 offset:11744
    buffer_load_dwordx4 v[168:171], v8, s[8:11], 0 offen
    v_mfma_f32_16x16x32_bf16 v[52:55], v[216:219], v[32:35], v[52:55]
    v_mfma_f32_16x16x32_bf16 v[56:59], v[220:223], v[32:35], v[56:59]
    s_waitcnt lgkmcnt(6)
    v_mfma_f32_16x16x32_bf16 v[48:51], v[224:227], v[36:39], v[48:51]
    ds_read_b128 v[32:35], v1 offset:13344
    v_mfma_f32_16x16x32_bf16 v[52:55], v[228:231], v[36:39], v[52:55]
    v_mfma_f32_16x16x32_bf16 v[56:59], v[232:235], v[36:39], v[56:59]
    buffer_load_dwordx4 v[172:175], v8, s[8:11], 0 offen offset:64
    s_waitcnt lgkmcnt(6)
    v_mfma_f32_16x16x32_bf16 v[48:51], v[236:239], v[40:43], v[48:51]
    v_mfma_f32_16x16x32_bf16 v[52:55], v[240:243], v[40:43], v[52:55]
    v_mfma_f32_16x16x32_bf16 v[56:59], v[244:247], v[40:43], v[56:59]
    s_waitcnt lgkmcnt(5)
    v_mfma_f32_16x16x32_bf16 v[60:63], v[212:215], v[44:47], v[60:63]
    v_mfma_f32_16x16x32_bf16 v[64:67], v[216:219], v[44:47], v[64:67]
    buffer_load_dwordx4 v[176:179], v8, s[8:11], 0 offen offset:128
    v_mfma_f32_16x16x32_bf16 v[68:71], v[220:223], v[44:47], v[68:71]
    s_waitcnt lgkmcnt(4)
    v_mfma_f32_16x16x32_bf16 v[60:63], v[224:227], v[16:19], v[60:63]
    v_mfma_f32_16x16x32_bf16 v[64:67], v[228:231], v[16:19], v[64:67]
    v_mfma_f32_16x16x32_bf16 v[68:71], v[232:235], v[16:19], v[68:71]
    s_waitcnt lgkmcnt(3)
    v_mfma_f32_16x16x32_bf16 v[60:63], v[236:239], v[20:23], v[60:63]
    v_add_u32 v6, 0x24000, v6
    v_mfma_f32_16x16x32_bf16 v[64:67], v[240:243], v[20:23], v[64:67]
    v_mfma_f32_16x16x32_bf16 v[68:71], v[244:247], v[20:23], v[68:71]
    s_waitcnt lgkmcnt(2)
    v_mfma_f32_16x16x32_bf16 v[72:75], v[212:215], v[24:27], v[72:75]
    v_cvt_pk_bf16_f32 v248, v48, v49
    v_mfma_f32_16x16x32_bf16 v[76:79], v[216:219], v[24:27], v[76:79]
    v_cvt_pk_bf16_f32 v249, v50, v51
    v_mfma_f32_16x16x32_bf16 v[80:83], v[220:223], v[24:27], v[80:83]
    v_add_u32 v8, 0x9000, v8
    v_cvt_pk_bf16_f32 v250, v52, v53
    s_waitcnt lgkmcnt(1)
    v_mfma_f32_16x16x32_bf16 v[72:75], v[224:227], v[28:31], v[72:75]
    v_cvt_pk_bf16_f32 v251, v54, v55
    v_mfma_f32_16x16x32_bf16 v[76:79], v[228:231], v[28:31], v[76:79]
    v_cvt_pk_bf16_f32 v252, v56, v57
    v_mfma_f32_16x16x32_bf16 v[80:83], v[232:235], v[28:31], v[80:83]
    v_cvt_pk_bf16_f32 v253, v58, v59
    s_waitcnt lgkmcnt(0)
    v_mfma_f32_16x16x32_bf16 v[72:75], v[236:239], v[32:35], v[72:75]
    buffer_store_dwordx4 v[248:251], v3, s[20:23], s29 offen
    v_mfma_f32_16x16x32_bf16 v[76:79], v[240:243], v[32:35], v[76:79]
    buffer_store_dwordx2 v[252:253], v4, s[20:23], s29 offen
    v_mfma_f32_16x16x32_bf16 v[80:83], v[244:247], v[32:35], v[80:83]
    v_cvt_pk_bf16_f32 v248, v60, v61
    v_cvt_pk_bf16_f32 v249, v62, v63
    v_cvt_pk_bf16_f32 v250, v64, v65
    v_cvt_pk_bf16_f32 v251, v66, v67
    v_cvt_pk_bf16_f32 v252, v68, v69
    v_cvt_pk_bf16_f32 v253, v70, v71
    buffer_store_dwordx4 v[248:251], v3, s[20:23], s47 offen
    buffer_store_dwordx2 v[252:253], v4, s[20:23], s47 offen
    ds_read_b128 v[16:19], v1 offset:9600
    ds_read_b128 v[20:23], v1 offset:11200
    ds_read_b128 v[24:27], v1 offset:12800
    ds_read_b128 v[28:31], v1 offset:9616
    ds_read_b128 v[32:35], v1 offset:11216
    ds_read_b128 v[36:39], v1 offset:12816
    ds_read_b128 v[40:43], v1 offset:9632
    s_add_u32 s55, s29, 6144
    s_add_u32 s29, s29, 147456
    v_add_u32 v1, 9600, v1
    s_add_u32 s31, s31, 1
    s_barrier
L_loopA:
    s_add_u32 s47, s29, 3072
    s_waitcnt lgkmcnt(6)
    v_mfma_f32_16x16x32_bf16 v[48:51], a[0:3], v[16:19], 0
    ds_read_b128 v[44:47], v1 offset:1632
    v_mfma_f32_16x16x32_bf16 v[52:55], a[4:7], v[16:19], 0
    v_mfma_f32_16x16x32_bf16 v[56:59], a[8:11], v[16:19], 0
    v_cvt_pk_bf16_f32 v248, v72, v73
    s_waitcnt lgkmcnt(6)
    v_mfma_f32_16x16x32_bf16 v[48:51], a[12:15], v[20:23], v[48:51]
    ds_read_b128 v[16:19], v1 offset:3232
    v_mfma_f32_16x16x32_bf16 v[52:55], a[16:19], v[20:23], v[52:55]
    v_cvt_pk_bf16_f32 v249, v74, v75
    v_mfma_f32_16x16x32_bf16 v[56:59], a[20:23], v[20:23], v[56:59]
    s_waitcnt lgkmcnt(6)
    v_mfma_f32_16x16x32_bf16 v[48:51], a[24:27], v[24:27], v[48:51]
    ds_read_b128 v[20:23], v1 offset:4800
    v_mfma_f32_16x16x32_bf16 v[52:55], a[28:31], v[24:27], v[52:55]
    v_cvt_pk_bf16_f32 v250, v76, v77
    v_mfma_f32_16x16x32_bf16 v[56:59], a[32:35], v[24:27], v[56:59]
    s_waitcnt lgkmcnt(6)
    v_mfma_f32_16x16x32_bf16 v[48:51], a[36:39], v[28:31], v[48:51]
    ds_read_b128 v[24:27], v1 offset:6400
    v_mfma_f32_16x16x32_bf16 v[52:55], a[40:43], v[28:31], v[52:55]
    v_cvt_pk_bf16_f32 v251, v78, v79
    v_mfma_f32_16x16x32_bf16 v[56:59], a[44:47], v[28:31], v[56:59]
    s_waitcnt lgkmcnt(6)
    v_mfma_f32_16x16x32_bf16 v[48:51], a[48:51], v[32:35], v[48:51]
    ds_read_b128 v[28:31], v1 offset:8000
    v_mfma_f32_16x16x32_bf16 v[52:55], a[52:55], v[32:35], v[52:55]
    v_cvt_pk_bf16_f32 v252, v80, v81
    v_mfma_f32_16x16x32_bf16 v[56:59], a[56:59], v[32:35], v[56:59]
    s_waitcnt lgkmcnt(6)
    v_mfma_f32_16x16x32_bf16 v[48:51], a[60:63], v[36:39], v[48:51]
    ds_read_b128 v[32:35], v1 offset:4816
    v_mfma_f32_16x16x32_bf16 v[52:55], a[64:67], v[36:39], v[52:55]
    v_cvt_pk_bf16_f32 v253, v82, v83
    v_mfma_f32_16x16x32_bf16 v[56:59], a[68:71], v[36:39], v[56:59]
    s_waitcnt lgkmcnt(6)
    v_mfma_f32_16x16x32_bf16 v[48:51], a[72:75], v[40:43], v[48:51]
    ds_read_b128 v[36:39], v1 offset:6416
    v_mfma_f32_16x16x32_bf16 v[52:55], a[76:79], v[40:43], v[52:55]
    buffer_store_dwordx4 v[248:251], v3, s[20:23], s55 offen
    v_mfma_f32_16x16x32_bf16 v[56:59], a[80:83], v[40:43], v[56:59]
    s_waitcnt lgkmcnt(6)
    v_mfma_f32_16x16x32_bf16 v[48:51], a[84:87], v[44:47], v[48:51]
    ds_read_b128 v[40:43], v1 offset:8016
    v_mfma_f32_16x16x32_bf16 v[52:55], a[88:91], v[44:47], v[52:55]
    buffer_store_dwordx2 v[252:253], v4, s[20:23], s55 offen
    v_mfma_f32_16x16x32_bf16 v[56:59], a[92:95], v[44:47], v[56:59]
    s_waitcnt lgkmcnt(6)
    v_mfma_f32_16x16x32_bf16 v[48:51], a[96:99], v[16:19], v[48:51]
    ds_read_b128 v[44:47], v1 offset:4832
    v_mfma_f32_16x16x32_bf16 v[52:55], a[100:103], v[16:19], v[52:55]
    s_waitcnt vmcnt(12)
    v_lshlrev_b32 v84, 16, v144
    v_mfma_f32_16x16x32_bf16 v[56:59], a[104:107], v[16:19], v[56:59]
    v_and_b32 v85, 0xffff0000, v144
    s_waitcnt lgkmcnt(6)
    v_mfma_f32_16x16x32_bf16 v[48:51], a[108:111], v[20:23], v[48:51]
    ds_read_b128 v[16:19], v1 offset:6432
    v_lshlrev_b32 v86, 16, v145
    v_mfma_f32_16x16x32_bf16 v[52:55], a[112:115], v[20:23], v[52:55]
    v_and_b32 v87, 0xffff0000, v145
    v_mfma_f32_16x16x32_bf16 v[56:59], a[116:119], v[20:23], v[56:59]
    v_lshlrev_b32 v88, 16, v146
    s_waitcnt lgkmcnt(6)
    v_mfma_f32_16x16x32_bf16 v[48:51], a[120:123], v[24:27], v[48:51]
    ds_read_b128 v[20:23], v1 offset:8032
    v_and_b32 v89, 0xffff0000, v146
    v_mfma_f32_16x16x32_bf16 v[52:55], a[124:127], v[24:27], v[52:55]
    v_lshlrev_b32 v90, 16, v147
    v_mfma_f32_16x16x32_bf16 v[56:59], a[128:131], v[24:27], v[56:59]
    v_and_b32 v91, 0xffff0000, v147
    s_waitcnt lgkmcnt(6)
    v_mfma_f32_16x16x32_bf16 v[48:51], a[132:135], v[28:31], v[48:51]
    ds_read_b128 v[24:27], v1 offset:9600
    s_waitcnt vmcnt(11)
    v_lshlrev_b32 v92, 16, v148
    v_mfma_f32_16x16x32_bf16 v[52:55], a[136:139], v[28:31], v[52:55]
    v_and_b32 v93, 0xffff0000, v148
    v_mfma_f32_16x16x32_bf16 v[56:59], a[140:143], v[28:31], v[56:59]
    s_waitcnt lgkmcnt(6)
    v_mfma_f32_16x16x32_bf16 v[48:51], a[144:147], v[32:35], v[48:51]
    ds_read_b128 v[28:31], v1 offset:11200
    v_lshlrev_b32 v94, 16, v149
    v_mfma_f32_16x16x32_bf16 v[52:55], a[148:151], v[32:35], v[52:55]
    v_and_b32 v95, 0xffff0000, v149
    v_mfma_f32_16x16x32_bf16 v[56:59], a[152:155], v[32:35], v[56:59]
    v_lshlrev_b32 v96, 16, v150
    s_waitcnt lgkmcnt(6)
    v_mfma_f32_16x16x32_bf16 v[48:51], a[156:159], v[36:39], v[48:51]
    ds_read_b128 v[32:35], v1 offset:12800
    v_and_b32 v97, 0xffff0000, v150
    v_mfma_f32_16x16x32_bf16 v[52:55], a[160:163], v[36:39], v[52:55]
    v_lshlrev_b32 v98, 16, v151
    v_mfma_f32_16x16x32_bf16 v[56:59], a[164:167], v[36:39], v[56:59]
    v_and_b32 v99, 0xffff0000, v151
    s_waitcnt lgkmcnt(6)
    v_mfma_f32_16x16x32_bf16 v[48:51], a[168:171], v[40:43], v[48:51]
    ds_read_b128 v[36:39], v1 offset:9616
    s_waitcnt vmcnt(10)
    v_lshlrev_b32 v100, 16, v152
    v_mfma_f32_16x16x32_bf16 v[52:55], a[172:175], v[40:43], v[52:55]
    v_and_b32 v101, 0xffff0000, v152
    v_mfma_f32_16x16x32_bf16 v[56:59], a[176:179], v[40:43], v[56:59]
    v_lshlrev_b32 v102, 16, v153
    s_waitcnt lgkmcnt(6)
    v_mfma_f32_16x16x32_bf16 v[48:51], a[180:183], v[44:47], v[48:51]
    ds_read_b128 v[40:43], v1 offset:11216
    v_and_b32 v103, 0xffff0000, v153
    v_mfma_f32_16x16x32_bf16 v[52:55], a[184:187], v[44:47], v[52:55]
    v_mfma_f32_16x16x32_bf16 v[56:59], a[188:191], v[44:47], v[56:59]
    v_lshlrev_b32 v104, 16, v154
    s_waitcnt lgkmcnt(6)
    v_mfma_f32_16x16x32_bf16 v[48:51], a[192:195], v[16:19], v[48:51]
    ds_read_b128 v[44:47], v1 offset:12816
    v_and_b32 v105, 0xffff0000, v154
    v_mfma_f32_16x16x32_bf16 v[52:55], a[196:199], v[16:19], v[52:55]
    v_lshlrev_b32 v106, 16, v155
    v_mfma_f32_16x16x32_bf16 v[56:59], a[200:203], v[16:19], v[56:59]
    v_and_b32 v107, 0xffff0000, v155
    s_waitcnt lgkmcnt(6)
    v_mfma_f32_16x16x32_bf16 v[48:51], a[204:207], v[20:23], v[48:51]
    ds_read_b128 v[16:19], v1 offset:9632
    s_waitcnt vmcnt(6)
    v_lshlrev_b32 v108, 16, v168
    v_mfma_f32_16x16x32_bf16 v[52:55], a[208:211], v[20:23], v[52:55]
    v_and_b32 v109, 0xffff0000, v168
    v_mfma_f32_16x16x32_bf16 v[56:59], a[212:215], v[20:23], v[56:59]
    v_lshlrev_b32 v110, 16, v169
    s_waitcnt lgkmcnt(6)
    v_mfma_f32_16x16x32_bf16 v[48:51], a[216:219], v[24:27], v[48:51]
    ds_read_b128 v[20:23], v1 offset:11232
    v_and_b32 v111, 0xffff0000, v169
    v_mfma_f32_16x16x32_bf16 v[52:55], a[220:223], v[24:27], v[52:55]
    v_lshlrev_b32 v112, 16, v170
    v_mfma_f32_16x16x32_bf16 v[56:59], a[224:227], v[24:27], v[56:59]
    s_waitcnt lgkmcnt(6)
    v_mfma_f32_16x16x32_bf16 v[48:51], a[228:231], v[28:31], v[48:51]
    ds_read_b128 v[24:27], v1 offset:12832
    v_and_b32 v113, 0xffff0000, v170
    v_mfma_f32_16x16x32_bf16 v[52:55], a[232:235], v[28:31], v[52:55]
    v_lshlrev_b32 v114, 16, v171
    v_mfma_f32_16x16x32_bf16 v[56:59], a[236:239], v[28:31], v[56:59]
    v_and_b32 v115, 0xffff0000, v171
    s_waitcnt lgkmcnt(6)
    v_mfma_f32_16x16x32_bf16 v[48:51], a[240:243], v[32:35], v[48:51]
    ds_read_b128 v[28:31], v2 offset:0
    s_waitcnt vmcnt(5)
    v_lshlrev_b32 v116, 16, v172
    v_mfma_f32_16x16x32_bf16 v[52:55], a[244:247], v[32:35], v[52:55]
    v_and_b32 v117, 0xffff0000, v172
    v_mfma_f32_16x16x32_bf16 v[56:59], a[248:251], v[32:35], v[56:59]
    v_lshlrev_b32 v118, 16, v173
    s_waitcnt lgkmcnt(6)
    v_mfma_f32_16x16x32_bf16 v[48:51], a[252:255], v[36:39], v[48:51]
    ds_read_b128 v[32:35], v2 offset:3072
    v_and_b32 v119, 0xffff0000, v173
    v_mfma_f32_16x16x32_bf16 v[52:55], v[180:183], v[36:39], v[52:55]
    v_lshlrev_b32 v120, 16, v174
    v_mfma_f32_16x16x32_bf16 v[56:59], v[184:187], v[36:39], v[56:59]
    v_and_b32 v121, 0xffff0000, v174
    s_waitcnt lgkmcnt(6)
    v_mfma_f32_16x16x32_bf16 v[48:51], v[188:191], v[40:43], v[48:51]
    ds_read_b128 v[36:39], v2 offset:6144
    v_lshlrev_b32 v122, 16, v175
    v_mfma_f32_16x16x32_bf16 v[52:55], v[192:195], v[40:43], v[52:55]
    v_mfma_f32_16x16x32_bf16 v[56:59], v[196:199], v[40:43], v[56:59]
    v_and_b32 v123, 0xffff0000, v175
    s_waitcnt lgkmcnt(6)
    v_mfma_f32_16x16x32_bf16 v[48:51], v[200:203], v[44:47], v[48:51]
    ds_read_b128 v[40:43], v2 offset:9216
    s_waitcnt vmcnt(2)
    v_lshlrev_b32 v124, 16, v176
    v_mfma_f32_16x16x32_bf16 v[52:55], v[204:207], v[44:47], v[52:55]
    v_and_b32 v125, 0xffff0000, v176
    v_mfma_f32_16x16x32_bf16 v[56:59], v[208:211], v[44:47], v[56:59]
    v_lshlrev_b32 v126, 16, v177
    s_waitcnt lgkmcnt(6)
    v_mfma_f32_16x16x32_bf16 v[48:51], v[212:215], v[16:19], v[48:51]
    ds_read_b128 v[44:47], v2 offset:12288
    v_and_b32 v127, 0xffff0000, v177
    v_mfma_f32_16x16x32_bf16 v[52:55], v[216:219], v[16:19], v[52:55]
    v_lshlrev_b32 v128, 16, v178
    v_mfma_f32_16x16x32_bf16 v[56:59], v[220:223], v[16:19], v[56:59]
    v_and_b32 v129, 0xffff0000, v178
    s_waitcnt lgkmcnt(6)
    v_mfma_f32_16x16x32_bf16 v[48:51], v[224:227], v[20:23], v[48:51]
    ds_read_b128 v[16:19], v2 offset:15360
    v_lshlrev_b32 v130, 16, v179
    v_mfma_f32_16x16x32_bf16 v[52:55], v[228:231], v[20:23], v[52:55]
    v_and_b32 v131, 0xffff0000, v179
    v_mfma_f32_16x16x32_bf16 v[56:59], v[232:235], v[20:23], v[56:59]
    s_waitcnt lgkmcnt(6)
    v_mfma_f32_16x16x32_bf16 v[48:51], v[236:239], v[24:27], v[48:51]
    ds_read_b128 v[20:23], v2 offset:1024
    v_mfma_f32_16x16x32_bf16 v[52:55], v[240:243], v[24:27], v[52:55]
    v_mfma_f32_16x16x32_bf16 v[56:59], v[244:247], v[24:27], v[56:59]
    s_waitcnt lgkmcnt(6)
    v_mfma_f32_16x16x32_bf16 v[84:87], v[28:31], v[132:135], v[84:87]
    ds_read_b128 v[24:27], v2 offset:4096
    v_mfma_f32_16x16x32_bf16 v[108:111], v[28:31], v[156:159], v[108:111]
    s_waitcnt lgkmcnt(6)
    v_mfma_f32_16x16x32_bf16 v[88:91], v[32:35], v[132:135], v[88:91]
    ds_read_b128 v[28:31], v2 offset:7168
    v_mfma_f32_16x16x32_bf16 v[112:115], v[32:35], v[156:159], v[112:115]
    s_waitcnt lgkmcnt(6)
    v_mfma_f32_16x16x32_bf16 v[92:95], v[36:39], v[132:135], v[92:95]
    ds_read_b128 v[32:35], v2 offset:10240
    v_mfma_f32_16x16x32_bf16 v[116:119], v[36:39], v[156:159], v[116:119]
    s_waitcnt lgkmcnt(6)
    v_mfma_f32_16x16x32_bf16 v[96:99], v[40:43], v[132:135], v[96:99]
    ds_read_b128 v[36:39], v2 offset:13312
    v_mfma_f32_16x16x32_bf16 v[120:123], v[40:43], v[156:159], v[120:123]
    s_waitcnt lgkmcnt(6)
    v_mfma_f32_16x16x32_bf16 v[100:103], v[44:47], v[132:135], v[100:103]
    ds_read_b128 v[40:43], v2 offset:16384
    v_mfma_f32_16x16x32_bf16 v[124:127], v[44:47], v[156:159], v[124:127]
    s_waitcnt lgkmcnt(6)
    v_mfma_f32_16x16x32_bf16 v[104:107], v[16:19], v[132:135], v[104:107]
    ds_read_b128 v[44:47], v2 offset:2048
    v_mfma_f32_16x16x32_bf16 v[128:131], v[16:19], v[156:159], v[128:131]
    v_cvt_pk_bf16_f32 v248, v48, v49
    s_waitcnt lgkmcnt(6)
    v_mfma_f32_16x16x32_bf16 v[84:87], v[20:23], v[136:139], v[84:87]
    ds_read_b128 v[16:19], v2 offset:5120
    v_mfma_f32_16x16x32_bf16 v[108:111], v[20:23], v[160:163], v[108:111]
    v_cvt_pk_bf16_f32 v249, v50, v51
    s_waitcnt lgkmcnt(6)
    v_mfma_f32_16x16x32_bf16 v[88:91], v[24:27], v[136:139], v[88:91]
    ds_read_b128 v[20:23], v2 offset:8192
    v_mfma_f32_16x16x32_bf16 v[112:115], v[24:27], v[160:163], v[112:115]
    s_waitcnt lgkmcnt(6)
    v_mfma_f32_16x16x32_bf16 v[92:95], v[28:31], v[136:139], v[92:95]
    ds_read_b128 v[24:27], v2 offset:11264
    v_cvt_pk_bf16_f32 v250, v52, v53
    v_mfma_f32_16x16x32_bf16 v[116:119], v[28:31], v[160:163], v[116:119]
    s_waitcnt lgkmcnt(6)
    v_mfma_f32_16x16x32_bf16 v[96:99], v[32:35], v[136:139], v[96:99]
    ds_read_b128 v[28:31], v2 offset:14336
    v_mfma_f32_16x16x32_bf16 v[120:123], v[32:35], v[160:163], v[120:123]
    v_cvt_pk_bf16_f32 v251, v54, v55
    s_waitcnt lgkmcnt(6)
    v_mfma_f32_16x16x32_bf16 v[100:103], v[36:39], v[136:139], v[100:103]
    ds_read_b128 v[32:35], v2 offset:17408
    v_mfma_f32_16x16x32_bf16 v[124:127], v[36:39], v[160:163], v[124:127]
    s_waitcnt lgkmcnt(6)
    v_mfma_f32_16x16x32_bf16 v[104:107], v[40:43], v[136:139], v[104:107]
    ds_read_b128 v[36:39], v1 offset:256
    v_cvt_pk_bf16_f32 v252, v56, v57
    v_mfma_f32_16x16x32_bf16 v[128:131], v[40:43], v[160:163], v[128:131]
    s_waitcnt lgkmcnt(6)
    v_mfma_f32_16x16x32_bf16 v[84:87], v[44:47], v[140:143], v[84:87]
    ds_read_b128 v[40:43], v1 offset:1856
    v_mfma_f32_16x16x32_bf16 v[108:111], v[44:47], v[164:167], v[108:111]
    v_cvt_pk_bf16_f32 v253, v58, v59
    s_waitcnt lgkmcnt(6)
    v_mfma_f32_16x16x32_bf16 v[88:91], v[16:19], v[140:143], v[88:91]
    ds_read_b128 v[44:47], v1 offset:3456
    v_mfma_f32_16x16x32_bf16 v[112:115], v[16:19], v[164:167], v[112:115]
    s_waitcnt lgkmcnt(6)
    v_mfma_f32_16x16x32_bf16 v[92:95], v[20:23], v[140:143], v[92:95]
    ds_read_b128 v[16:19], v1 offset:272
    buffer_store_dwordx4 v[248:251], v3, s[20:23], s29 offen
    v_mfma_f32_16x16x32_bf16 v[116:119], v[20:23], v[164:167], v[116:119]
    s_waitcnt lgkmcnt(6)
    v_mfma_f32_16x16x32_bf16 v[96:99], v[24:27], v[140:143], v[96:99]
    ds_read_b128 v[20:23], v1 offset:1872
    v_mfma_f32_16x16x32_bf16 v[120:123], v[24:27], v[164:167], v[120:123]
    buffer_store_dwordx2 v[252:253], v4, s[20:23], s29 offen
    s_waitcnt lgkmcnt(6)
    v_mfma_f32_16x16x32_bf16 v[100:103], v[28:31], v[140:143], v[100:103]
    ds_read_b128 v[24:27], v1 offset:3472
    v_mfma_f32_16x16x32_bf16 v[124:127], v[28:31], v[164:167], v[124:127]
    s_waitcnt lgkmcnt(6)
    v_mfma_f32_16x16x32_bf16 v[104:107], v[32:35], v[140:143], v[104:107]
    ds_read_b128 v[28:31], v1 offset:288
    v_mfma_f32_16x16x32_bf16 v[128:131], v[32:35], v[164:167], v[128:131]
    s_waitcnt lgkmcnt(6)
    v_mfma_f32_16x16x32_bf16 v[60:63], a[0:3], v[36:39], 0
    ds_read_b128 v[32:35], v1 offset:1888
    buffer_load_dwordx4 v[132:135], v5, s[4:7], 0 offen
    v_mfma_f32_16x16x32_bf16 v[64:67], a[4:7], v[36:39], 0
    v_mfma_f32_16x16x32_bf16 v[68:71], a[8:11], v[36:39], 0
    s_waitcnt lgkmcnt(6)
    v_mfma_f32_16x16x32_bf16 v[60:63], a[12:15], v[40:43], v[60:63]
    ds_read_b128 v[36:39], v1 offset:3488
    v_mfma_f32_16x16x32_bf16 v[64:67], a[16:19], v[40:43], v[64:67]
    v_mfma_f32_16x16x32_bf16 v[68:71], a[20:23], v[40:43], v[68:71]
    s_waitcnt lgkmcnt(6)
    v_mfma_f32_16x16x32_bf16 v[60:63], a[24:27], v[44:47], v[60:63]
    ds_read_b128 v[40:43], v1 offset:5056
    v_mfma_f32_16x16x32_bf16 v[64:67], a[28:31], v[44:47], v[64:67]
    v_mfma_f32_16x16x32_bf16 v[68:71], a[32:35], v[44:47], v[68:71]
    s_waitcnt lgkmcnt(6)
    v_mfma_f32_16x16x32_bf16 v[60:63], a[36:39], v[16:19], v[60:63]
    ds_read_b128 v[44:47], v1 offset:6656
    buffer_load_dwordx4 v[136:139], v5, s[4:7], 0 offen offset:64
    v_mfma_f32_16x16x32_bf16 v[64:67], a[40:43], v[16:19], v[64:67]
    v_mfma_f32_16x16x32_bf16 v[68:71], a[44:47], v[16:19], v[68:71]
    v_cvt_pk_bf16_f32 v84, v84, v85
    s_waitcnt lgkmcnt(6)
    v_mfma_f32_16x16x32_bf16 v[60:63], a[48:51], v[20:23], v[60:63]
    ds_read_b128 v[16:19], v1 offset:8256
    v_cvt_pk_bf16_f32 v85, v86, v87
    v_mfma_f32_16x16x32_bf16 v[64:67], a[52:55], v[20:23], v[64:67]
    v_cvt_pk_bf16_f32 v86, v88, v89
    v_mfma_f32_16x16x32_bf16 v[68:71], a[56:59], v[20:23], v[68:71]
    v_cvt_pk_bf16_f32 v87, v90, v91
    s_waitcnt lgkmcnt(6)
    v_mfma_f32_16x16x32_bf16 v[60:63], a[60:63], v[24:27], v[60:63]
    ds_read_b128 v[20:23], v1 offset:5072
    ds_write_b128 v9, v[84:87] offset:0
    v_mfma_f32_16x16x32_bf16 v[64:67], a[64:67], v[24:27], v[64:67]
    v_mfma_f32_16x16x32_bf16 v[68:71], a[68:71], v[24:27], v[68:71]
    v_cvt_pk_bf16_f32 v92, v92, v93
    s_waitcnt lgkmcnt(7)
    v_mfma_f32_16x16x32_bf16 v[60:63], a[72:75], v[28:31], v[60:63]
    ds_read_b128 v[24:27], v1 offset:6672
    buffer_load_dwordx4 v[140:143], v5, s[4:7], 0 offen offset:128
    v_cvt_pk_bf16_f32 v93, v94, v95
    v_mfma_f32_16x16x32_bf16 v[64:67], a[76:79], v[28:31], v[64:67]
    v_cvt_pk_bf16_f32 v94, v96, v97
    v_mfma_f32_16x16x32_bf16 v[68:71], a[80:83], v[28:31], v[68:71]
    v_cvt_pk_bf16_f32 v95, v98, v99
    s_waitcnt lgkmcnt(7)
    v_mfma_f32_16x16x32_bf16 v[60:63], a[84:87], v[32:35], v[60:63]
    ds_read_b128 v[28:31], v1 offset:8272
    ds_write_b128 v9, v[92:95] offset:1600
    v_mfma_f32_16x16x32_bf16 v[64:67], a[88:91], v[32:35], v[64:67]
    v_mfma_f32_16x16x32_bf16 v[68:71], a[92:95], v[32:35], v[68:71]
    v_cvt_pk_bf16_f32 v100, v100, v101
    s_waitcnt lgkmcnt(8)
    v_mfma_f32_16x16x32_bf16 v[60:63], a[96:99], v[36:39], v[60:63]
    ds_read_b128 v[32:35], v1 offset:5088
    v_cvt_pk_bf16_f32 v101, v102, v103
    v_mfma_f32_16x16x32_bf16 v[64:67], a[100:103], v[36:39], v[64:67]
    v_cvt_pk_bf16_f32 v102, v104, v105
    v_mfma_f32_16x16x32_bf16 v[68:71], a[104:107], v[36:39], v[68:71]
    v_cvt_pk_bf16_f32 v103, v106, v107
    s_waitcnt lgkmcnt(8)
    v_mfma_f32_16x16x32_bf16 v[60:63], a[108:111], v[40:43], v[60:63]
    ds_read_b128 v[36:39], v1 offset:6688
    v_mfma_f32_16x16x32_bf16 v[64:67], a[112:115], v[40:43], v[64:67]
    buffer_load_dwordx4 v[144:147], v7, s[8:11], 0 offen
    ds_write_b128 v9, v[100:103] offset:3200
    v_mfma_f32_16x16x32_bf16 v[68:71], a[116:119], v[40:43], v[68:71]
    v_add_u32 v9, v9, v11
    s_waitcnt lgkmcnt(9)
    v_mfma_f32_16x16x32_bf16 v[60:63], a[120:123], v[44:47], v[60:63]
    ds_read_b128 v[40:43], v1 offset:8288
    v_cvt_pk_bf16_f32 v108, v108, v109
    v_mfma_f32_16x16x32_bf16 v[64:67], a[124:127], v[44:47], v[64:67]
    v_cvt_pk_bf16_f32 v109, v110, v111
    v_mfma_f32_16x16x32_bf16 v[68:71], a[128:131], v[44:47], v[68:71]
    v_cvt_pk_bf16_f32 v110, v112, v113
    s_waitcnt lgkmcnt(9)
    v_mfma_f32_16x16x32_bf16 v[60:63], a[132:135], v[16:19], v[60:63]
    ds_read_b128 v[44:47], v1 offset:9856
    v_mfma_f32_16x16x32_bf16 v[64:67], a[136:139], v[16:19], v[64:67]
    v_cvt_pk_bf16_f32 v111, v114, v115
    v_mfma_f32_16x16x32_bf16 v[68:71], a[140:143], v[16:19], v[68:71]
    ds_write_b128 v10, v[108:111] offset:0
    s_waitcnt lgkmcnt(10)
    v_mfma_f32_16x16x32_bf16 v[60:63], a[144:147], v[20:23], v[60:63]
    ds_read_b128 v[16:19], v1 offset:11456
    v_cvt_pk_bf16_f32 v116, v116, v117
    v_mfma_f32_16x16x32_bf16 v[64:67], a[148:151], v[20:23], v[64:67]
    buffer_load_dwordx4 v[148:151], v7, s[8:11], 0 offen offset:64
    v_cvt_pk_bf16_f32 v117, v118, v119
    v_mfma_f32_16x16x32_bf16 v[68:71], a[152:155], v[20:23], v[68:71]
    s_waitcnt lgkmcnt(9)
    v_mfma_f32_16x16x32_bf16 v[60:63], a[156:159], v[24:27], v[60:63]
    ds_read_b128 v[20:23], v1 offset:13056
    v_cvt_pk_bf16_f32 v118, v120, v121
    v_mfma_f32_16x16x32_bf16 v[64:67], a[160:163], v[24:27], v[64:67]
    v_cvt_pk_bf16_f32 v119, v122, v123
    v_mfma_f32_16x16x32_bf16 v[68:71], a[164:167], v[24:27], v[68:71]
    ds_write_b128 v10, v[116:119] offset:1600
    s_waitcnt lgkmcnt(10)
    v_mfma_f32_16x16x32_bf16 v[60:63], a[168:171], v[28:31], v[60:63]
    ds_read_b128 v[24:27], v1 offset:9872
    v_cvt_pk_bf16_f32 v124, v124, v125
    v_mfma_f32_16x16x32_bf16 v[64:67], a[172:175], v[28:31], v[64:67]
    v_cvt_pk_bf16_f32 v125, v126, v127
    v_mfma_f32_16x16x32_bf16 v[68:71], a[176:179], v[28:31], v[68:71]
    s_waitcnt lgkmcnt(9)
    v_mfma_f32_16x16x32_bf16 v[60:63], a[180:183], v[32:35], v[60:63]
    ds_read_b128 v[28:31], v1 offset:11472
    v_cvt_pk_bf16_f32 v126, v128, v129
    v_mfma_f32_16x16x32_bf16 v[64:67], a[184:187], v[32:35], v[64:67]
    buffer_load_dwordx4 v[152:155], v7, s[8:11], 0 offen offset:128
    v_cvt_pk_bf16_f32 v127, v130, v131
    v_mfma_f32_16x16x32_bf16 v[68:71], a[188:191], v[32:35], v[68:71]
    ds_write_b128 v10, v[124:127] offset:3200
    s_waitcnt lgkmcnt(10)
    v_mfma_f32_16x16x32_bf16 v[60:63], a[192:195], v[36:39], v[60:63]
    ds_read_b128 v[32:35], v1 offset:13072
    v_add_u32 v10, v10, v12
    v_mfma_f32_16x16x32_bf16 v[64:67], a[196:199], v[36:39], v[64:67]
    v_mfma_f32_16x16x32_bf16 v[68:71], a[200:203], v[36:39], v[68:71]
    s_waitcnt lgkmcnt(9)
    v_mfma_f32_16x16x32_bf16 v[60:63], a[204:207], v[40:43], v[60:63]
    ds_read_b128 v[36:39], v1 offset:9888
    v_mfma_f32_16x16x32_bf16 v[64:67], a[208:211], v[40:43], v[64:67]
    v_mfma_f32_16x16x32_bf16 v[68:71], a[212:215], v[40:43], v[68:71]
    s_waitcnt lgkmcnt(9)
    v_mfma_f32_16x16x32_bf16 v[60:63], a[216:219], v[44:47], v[60:63]
    ds_read_b128 v[40:43], v1 offset:11488
    v_mfma_f32_16x16x32_bf16 v[64:67], a[220:223], v[44:47], v[64:67]
    v_mfma_f32_16x16x32_bf16 v[68:71], a[224:227], v[44:47], v[68:71]
    v_add_u32 v5, 0x24000, v5
    s_waitcnt lgkmcnt(8)
    v_mfma_f32_16x16x32_bf16 v[60:63], a[228:231], v[16:19], v[60:63]
    ds_read_b128 v[44:47], v1 offset:13088
    v_mfma_f32_16x16x32_bf16 v[64:67], a[232:235], v[16:19], v[64:67]
    v_mfma_f32_16x16x32_bf16 v[68:71], a[236:239], v[16:19], v[68:71]
    s_waitcnt lgkmcnt(8)
    v_mfma_f32_16x16x32_bf16 v[60:63], a[240:243], v[20:23], v[60:63]
    ds_read_b128 v[16:19], v1 offset:512
    v_mfma_f32_16x16x32_bf16 v[64:67], a[244:247], v[20:23], v[64:67]
    v_mfma_f32_16x16x32_bf16 v[68:71], a[248:251], v[20:23], v[68:71]
    s_waitcnt lgkmcnt(7)
    v_mfma_f32_16x16x32_bf16 v[60:63], a[252:255], v[24:27], v[60:63]
    ds_read_b128 v[20:23], v1 offset:2112
    v_mfma_f32_16x16x32_bf16 v[64:67], v[180:183], v[24:27], v[64:67]
    v_mfma_f32_16x16x32_bf16 v[68:71], v[184:187], v[24:27], v[68:71]
    v_add_u32 v7, 0x9000, v7
    s_waitcnt lgkmcnt(7)
    v_mfma_f32_16x16x32_bf16 v[60:63], v[188:191], v[28:31], v[60:63]
    ds_read_b128 v[24:27], v1 offset:3712
    v_mfma_f32_16x16x32_bf16 v[64:67], v[192:195], v[28:31], v[64:67]
    v_mfma_f32_16x16x32_bf16 v[68:71], v[196:199], v[28:31], v[68:71]
    s_waitcnt lgkmcnt(6)
    v_mfma_f32_16x16x32_bf16 v[60:63], v[200:203], v[32:35], v[60:63]
    ds_read_b128 v[28:31], v1 offset:528
    v_mfma_f32_16x16x32_bf16 v[64:67], v[204:207], v[32:35], v[64:67]
    v_mfma_f32_16x16x32_bf16 v[68:71], v[208:211], v[32:35], v[68:71]
    s_waitcnt lgkmcnt(6)
    v_mfma_f32_16x16x32_bf16 v[60:63], v[212:215], v[36:39], v[60:63]
    ds_read_b128 v[32:35], v1 offset:2128
    v_mfma_f32_16x16x32_bf16 v[64:67], v[216:219], v[36:39], v[64:67]
    v_mfma_f32_16x16x32_bf16 v[68:71], v[220:223], v[36:39], v[68:71]
    s_waitcnt lgkmcnt(6)
    v_mfma_f32_16x16x32_bf16 v[60:63], v[224:227], v[40:43], v[60:63]
    ds_read_b128 v[36:39], v1 offset:3728
    buffer_load_dwordx4 v[156:159], v6, s[4:7], 0 offen
    v_mfma_f32_16x16x32_bf16 v[64:67], v[228:231], v[40:43], v[64:67]
    v_mfma_f32_16x16x32_bf16 v[68:71], v[232:235], v[40:43], v[68:71]
    s_waitcnt lgkmcnt(6)
    v_mfma_f32_16x16x32_bf16 v[60:63], v[236:239], v[44:47], v[60:63]
    ds_read_b128 v[40:43], v1 offset:544
    v_mfma_f32_16x16x32_bf16 v[64:67], v[240:243], v[44:47], v[64:67]
    v_mfma_f32_16x16x32_bf16 v[68:71], v[244:247], v[44:47], v[68:71]
    s_waitcnt lgkmcnt(6)
    v_mfma_f32_16x16x32_bf16 v[72:75], a[0:3], v[16:19], 0
    ds_read_b128 v[44:47], v1 offset:2144
    v_mfma_f32_16x16x32_bf16 v[76:79], a[4:7], v[16:19], 0
    v_mfma_f32_16x16x32_bf16 v[80:83], a[8:11], v[16:19], 0
    s_waitcnt lgkmcnt(6)
    v_mfma_f32_16x16x32_bf16 v[72:75], a[12:15], v[20:23], v[72:75]
    ds_read_b128 v[16:19], v1 offset:3744
    buffer_load_dwordx4 v[160:163], v6, s[4:7], 0 offen offset:64
    v_mfma_f32_16x16x32_bf16 v[76:79], a[16:19], v[20:23], v[76:79]
    v_mfma_f32_16x16x32_bf16 v[80:83], a[20:23], v[20:23], v[80:83]
    s_waitcnt lgkmcnt(6)
    v_mfma_f32_16x16x32_bf16 v[72:75], a[24:27], v[24:27], v[72:75]
    ds_read_b128 v[20:23], v1 offset:5312
    v_mfma_f32_16x16x32_bf16 v[76:79], a[28:31], v[24:27], v[76:79]
    v_mfma_f32_16x16x32_bf16 v[80:83], a[32:35], v[24:27], v[80:83]
    s_waitcnt lgkmcnt(6)
    v_mfma_f32_16x16x32_bf16 v[72:75], a[36:39], v[28:31], v[72:75]
    ds_read_b128 v[24:27], v1 offset:6912
    v_mfma_f32_16x16x32_bf16 v[76:79], a[40:43], v[28:31], v[76:79]
    v_cvt_pk_bf16_f32 v248, v60, v61
    v_mfma_f32_16x16x32_bf16 v[80:83], a[44:47], v[28:31], v[80:83]
    s_waitcnt lgkmcnt(6)
    v_mfma_f32_16x16x32_bf16 v[72:75], a[48:51], v[32:35], v[72:75]
    ds_read_b128 v[28:31], v1 offset:8512
    buffer_load_dwordx4 v[164:167], v6, s[4:7], 0 offen offset:128
    v_mfma_f32_16x16x32_bf16 v[76:79], a[52:55], v[32:35], v[76:79]
    v_mfma_f32_16x16x32_bf16 v[80:83], a[56:59], v[32:35], v[80:83]
    v_cvt_pk_bf16_f32 v249, v62, v63
    s_waitcnt lgkmcnt(6)
    v_mfma_f32_16x16x32_bf16 v[72:75], a[60:63], v[36:39], v[72:75]
    ds_read_b128 v[32:35], v1 offset:5328
    v_mfma_f32_16x16x32_bf16 v[76:79], a[64:67], v[36:39], v[76:79]
    v_mfma_f32_16x16x32_bf16 v[80:83], a[68:71], v[36:39], v[80:83]
    s_waitcnt lgkmcnt(6)
    v_mfma_f32_16x16x32_bf16 v[72:75], a[72:75], v[40:43], v[72:75]
    ds_read_b128 v[36:39], v1 offset:6928
    v_cvt_pk_bf16_f32 v250, v64, v65
    v_mfma_f32_16x16x32_bf16 v[76:79], a[76:79], v[40:43], v[76:79]
    v_mfma_f32_16x16x32_bf16 v[80:83], a[80:83], v[40:43], v[80:83]
    s_waitcnt lgkmcnt(6)
    v_mfma_f32_16x16x32_bf16 v[72:75], a[84:87], v[44:47], v[72:75]
    ds_read_b128 v[40:43], v1 offset:8528
    v_mfma_f32_16x16x32_bf16 v[76:79], a[88:91], v[44:47], v[76:79]
    buffer_load_dwordx4 v[168:171], v8, s[8:11], 0 offen
    v_cvt_pk_bf16_f32 v251, v66, v67
    v_mfma_f32_16x16x32_bf16 v[80:83], a[92:95], v[44:47], v[80:83]
    s_waitcnt lgkmcnt(6)
    v_mfma_f32_16x16x32_bf16 v[72:75], a[96:99], v[16:19], v[72:75]
    ds_read_b128 v[44:47], v1 offset:5344
    v_mfma_f32_16x16x32_bf16 v[76:79], a[100:103], v[16:19], v[76:79]
    v_mfma_f32_16x16x32_bf16 v[80:83], a[104:107], v[16:19], v[80:83]
    v_cvt_pk_bf16_f32 v252, v68, v69
    s_waitcnt lgkmcnt(6)
    v_mfma_f32_16x16x32_bf16 v[72:75], a[108:111], v[20:23], v[72:75]
    ds_read_b128 v[16:19], v1 offset:6944
    v_mfma_f32_16x16x32_bf16 v[76:79], a[112:115], v[20:23], v[76:79]
    v_mfma_f32_16x16x32_bf16 v[80:83], a[116:119], v[20:23], v[80:83]
    s_waitcnt lgkmcnt(6)
    v_mfma_f32_16x16x32_bf16 v[72:75], a[120:123], v[24:27], v[72:75]
    ds_read_b128 v[20:23], v1 offset:8544
    v_cvt_pk_bf16_f32 v253, v70, v71
    v_mfma_f32_16x16x32_bf16 v[76:79], a[124:127], v[24:27], v[76:79]
    buffer_load_dwordx4 v[172:175], v8, s[8:11], 0 offen offset:64
    v_mfma_f32_16x16x32_bf16 v[80:83], a[128:131], v[24:27], v[80:83]
    s_waitcnt lgkmcnt(6)
    v_mfma_f32_16x16x32_bf16 v[72:75], a[132:135], v[28:31], v[72:75]
    ds_read_b128 v[24:27], v1 offset:10112
    v_mfma_f32_16x16x32_bf16 v[76:79], a[136:139], v[28:31], v[76:79]
    buffer_store_dwordx4 v[248:251], v3, s[20:23], s47 offen
    v_mfma_f32_16x16x32_bf16 v[80:83], a[140:143], v[28:31], v[80:83]
    s_waitcnt lgkmcnt(6)
    v_mfma_f32_16x16x32_bf16 v[72:75], a[144:147], v[32:35], v[72:75]
    ds_read_b128 v[28:31], v1 offset:11712
    v_mfma_f32_16x16x32_bf16 v[76:79], a[148:151], v[32:35], v[76:79]
    v_mfma_f32_16x16x32_bf16 v[80:83], a[152:155], v[32:35], v[80:83]
    buffer_store_dwordx2 v[252:253], v4, s[20:23], s47 offen
    s_waitcnt lgkmcnt(6)
    v_mfma_f32_16x16x32_bf16 v[72:75], a[156:159], v[36:39], v[72:75]
    ds_read_b128 v[32:35], v1 offset:13312
    v_mfma_f32_16x16x32_bf16 v[76:79], a[160:163], v[36:39], v[76:79]
    buffer_load_dwordx4 v[176:179], v8, s[8:11], 0 offen offset:128
    v_mfma_f32_16x16x32_bf16 v[80:83], a[164:167], v[36:39], v[80:83]
    s_waitcnt lgkmcnt(6)
    v_mfma_f32_16x16x32_bf16 v[72:75], a[168:171], v[40:43], v[72:75]
    ds_read_b128 v[36:39], v1 offset:10128
    v_mfma_f32_16x16x32_bf16 v[76:79], a[172:175], v[40:43], v[76:79]
    v_mfma_f32_16x16x32_bf16 v[80:83], a[176:179], v[40:43], v[80:83]
    s_waitcnt lgkmcnt(6)
    v_mfma_f32_16x16x32_bf16 v[72:75], a[180:183], v[44:47], v[72:75]
    ds_read_b128 v[40:43], v1 offset:11728
    v_mfma_f32_16x16x32_bf16 v[76:79], a[184:187], v[44:47], v[76:79]
    v_mfma_f32_16x16x32_bf16 v[80:83], a[188:191], v[44:47], v[80:83]
    s_waitcnt lgkmcnt(6)
    v_mfma_f32_16x16x32_bf16 v[72:75], a[192:195], v[16:19], v[72:75]
    ds_read_b128 v[44:47], v1 offset:13328
    v_mfma_f32_16x16x32_bf16 v[76:79], a[196:199], v[16:19], v[76:79]
    v_mfma_f32_16x16x32_bf16 v[80:83], a[200:203], v[16:19], v[80:83]
    v_add_u32 v6, 0x24000, v6
    s_waitcnt lgkmcnt(6)
    v_mfma_f32_16x16x32_bf16 v[72:75], a[204:207], v[20:23], v[72:75]
    ds_read_b128 v[16:19], v1 offset:10144
    v_mfma_f32_16x16x32_bf16 v[76:79], a[208:211], v[20:23], v[76:79]
    v_mfma_f32_16x16x32_bf16 v[80:83], a[212:215], v[20:23], v[80:83]
    s_waitcnt lgkmcnt(6)
    v_mfma_f32_16x16x32_bf16 v[72:75], a[216:219], v[24:27], v[72:75]
    ds_read_b128 v[20:23], v1 offset:11744
    v_mfma_f32_16x16x32_bf16 v[76:79], a[220:223], v[24:27], v[76:79]
    v_mfma_f32_16x16x32_bf16 v[80:83], a[224:227], v[24:27], v[80:83]
    s_waitcnt lgkmcnt(6)
    v_mfma_f32_16x16x32_bf16 v[72:75], a[228:231], v[28:31], v[72:75]
    ds_read_b128 v[24:27], v1 offset:13344
    v_mfma_f32_16x16x32_bf16 v[76:79], a[232:235], v[28:31], v[76:79]
    v_mfma_f32_16x16x32_bf16 v[80:83], a[236:239], v[28:31], v[80:83]
    v_add_u32 v8, 0x9000, v8
    s_waitcnt lgkmcnt(6)
    v_mfma_f32_16x16x32_bf16 v[72:75], a[240:243], v[32:35], v[72:75]
    v_mfma_f32_16x16x32_bf16 v[76:79], a[244:247], v[32:35], v[76:79]
    v_mfma_f32_16x16x32_bf16 v[80:83], a[248:251], v[32:35], v[80:83]
    s_waitcnt lgkmcnt(5)
    v_mfma_f32_16x16x32_bf16 v[72:75], a[252:255], v[36:39], v[72:75]
    v_mfma_f32_16x16x32_bf16 v[76:79], v[180:183], v[36:39], v[76:79]
    v_mfma_f32_16x16x32_bf16 v[80:83], v[184:187], v[36:39], v[80:83]
    s_waitcnt lgkmcnt(4)
    v_mfma_f32_16x16x32_bf16 v[72:75], v[188:191], v[40:43], v[72:75]
    v_mfma_f32_16x16x32_bf16 v[76:79], v[192:195], v[40:43], v[76:79]
    v_mfma_f32_16x16x32_bf16 v[80:83], v[196:199], v[40:43], v[80:83]
    s_waitcnt lgkmcnt(3)
    v_mfma_f32_16x16x32_bf16 v[72:75], v[200:203], v[44:47], v[72:75]
    v_mfma_f32_16x16x32_bf16 v[76:79], v[204:207], v[44:47], v[76:79]
    v_mfma_f32_16x16x32_bf16 v[80:83], v[208:211], v[44:47], v[80:83]
    s_waitcnt lgkmcnt(2)
    v_mfma_f32_16x16x32_bf16 v[72:75], v[212:215], v[16:19], v[72:75]
    v_mfma_f32_16x16x32_bf16 v[76:79], v[216:219], v[16:19], v[76:79]
    v_mfma_f32_16x16x32_bf16 v[80:83], v[220:223], v[16:19], v[80:83]
    ds_read_b128 v[16:19], v1 offset:9600
    s_waitcnt lgkmcnt(2)
    v_mfma_f32_16x16x32_bf16 v[72:75], v[224:227], v[20:23], v[72:75]
    v_mfma_f32_16x16x32_bf16 v[76:79], v[228:231], v[20:23], v[76:79]
    v_mfma_f32_16x16x32_bf16 v[80:83], v[232:235], v[20:23], v[80:83]
    ds_read_b128 v[20:23], v1 offset:11200
    s_waitcnt lgkmcnt(2)
    v_mfma_f32_16x16x32_bf16 v[72:75], v[236:239], v[24:27], v[72:75]
    v_mfma_f32_16x16x32_bf16 v[76:79], v[240:243], v[24:27], v[76:79]
    v_mfma_f32_16x16x32_bf16 v[80:83], v[244:247], v[24:27], v[80:83]
    ds_read_b128 v[24:27], v1 offset:12800
    ds_read_b128 v[28:31], v1 offset:9616
    ds_read_b128 v[32:35], v1 offset:11216
    ds_read_b128 v[36:39], v1 offset:12816
    ds_read_b128 v[40:43], v1 offset:9632
    s_add_u32 s55, s29, 6144
    s_add_u32 s29, s29, 147456
    v_add_u32 v1, 9600, v1
    s_add_u32 s31, s31, 1
    s_barrier
    s_cmp_lt_u32 s31, 5
    s_cbranch_scc1 L_loopA
L_step5:
    s_add_u32 s47, s29, 3072
    s_waitcnt lgkmcnt(6)
    v_mfma_f32_16x16x32_bf16 v[48:51], a[0:3], v[16:19], 0
    ds_read_b128 v[44:47], v1 offset:1632
    v_mfma_f32_16x16x32_bf16 v[52:55], a[4:7], v[16:19], 0
    v_mfma_f32_16x16x32_bf16 v[56:59], a[8:11], v[16:19], 0
    v_cvt_pk_bf16_f32 v248, v72, v73
    s_waitcnt lgkmcnt(6)
    v_mfma_f32_16x16x32_bf16 v[48:51], a[12:15], v[20:23], v[48:51]
    ds_read_b128 v[16:19], v1 offset:3232
    v_mfma_f32_16x16x32_bf16 v[52:55], a[16:19], v[20:23], v[52:55]
    v_cvt_pk_bf16_f32 v249, v74, v75
    v_mfma_f32_16x16x32_bf16 v[56:59], a[20:23], v[20:23], v[56:59]
    s_waitcnt lgkmcnt(6)
    v_mfma_f32_16x16x32_bf16 v[48:51], a[24:27], v[24:27], v[48:51]
    ds_read_b128 v[20:23], v1 offset:4800
    v_mfma_f32_16x16x32_bf16 v[52:55], a[28:31], v[24:27], v[52:55]
    v_cvt_pk_bf16_f32 v250, v76, v77
    v_mfma_f32_16x16x32_bf16 v[56:59], a[32:35], v[24:27], v[56:59]
    s_waitcnt lgkmcnt(6)
    v_mfma_f32_16x16x32_bf16 v[48:51], a[36:39], v[28:31], v[48:51]
    ds_read_b128 v[24:27], v1 offset:6400
    v_mfma_f32_16x16x32_bf16 v[52:55], a[40:43], v[28:31], v[52:55]
    v_cvt_pk_bf16_f32 v251, v78, v79
    v_mfma_f32_16x16x32_bf16 v[56:59], a[44:47], v[28:31], v[56:59]
    s_waitcnt lgkmcnt(6)
    v_mfma_f32_16x16x32_bf16 v[48:51], a[48:51], v[32:35], v[48:51]
    ds_read_b128 v[28:31], v1 offset:8000
    v_mfma_f32_16x16x32_bf16 v[52:55], a[52:55], v[32:35], v[52:55]
    v_cvt_pk_bf16_f32 v252, v80, v81
    v_mfma_f32_16x16x32_bf16 v[56:59], a[56:59], v[32:35], v[56:59]
    s_waitcnt lgkmcnt(6)
    v_mfma_f32_16x16x32_bf16 v[48:51], a[60:63], v[36:39], v[48:51]
    ds_read_b128 v[32:35], v1 offset:4816
    v_mfma_f32_16x16x32_bf16 v[52:55], a[64:67], v[36:39], v[52:55]
    v_cvt_pk_bf16_f32 v253, v82, v83
    v_mfma_f32_16x16x32_bf16 v[56:59], a[68:71], v[36:39], v[56:59]
    s_waitcnt lgkmcnt(6)
    v_mfma_f32_16x16x32_bf16 v[48:51], a[72:75], v[40:43], v[48:51]
    ds_read_b128 v[36:39], v1 offset:6416
    v_mfma_f32_16x16x32_bf16 v[52:55], a[76:79], v[40:43], v[52:55]
    buffer_store_dwordx4 v[248:251], v3, s[20:23], s55 offen
    v_mfma_f32_16x16x32_bf16 v[56:59], a[80:83], v[40:43], v[56:59]
    s_waitcnt lgkmcnt(6)
    v_mfma_f32_16x16x32_bf16 v[48:51], a[84:87], v[44:47], v[48:51]
    ds_read_b128 v[40:43], v1 offset:8016
    v_mfma_f32_16x16x32_bf16 v[52:55], a[88:91], v[44:47], v[52:55]
    buffer_store_dwordx2 v[252:253], v4, s[20:23], s55 offen
    v_mfma_f32_16x16x32_bf16 v[56:59], a[92:95], v[44:47], v[56:59]
    s_waitcnt lgkmcnt(6)
    v_mfma_f32_16x16x32_bf16 v[48:51], a[96:99], v[16:19], v[48:51]
    ds_read_b128 v[44:47], v1 offset:4832
    v_mfma_f32_16x16x32_bf16 v[52:55], a[100:103], v[16:19], v[52:55]
    v_mfma_f32_16x16x32_bf16 v[56:59], a[104:107], v[16:19], v[56:59]
    s_waitcnt lgkmcnt(6)
    v_mfma_f32_16x16x32_bf16 v[48:51], a[108:111], v[20:23], v[48:51]
    ds_read_b128 v[16:19], v1 offset:6432
    v_mfma_f32_16x16x32_bf16 v[52:55], a[112:115], v[20:23], v[52:55]
    v_mfma_f32_16x16x32_bf16 v[56:59], a[116:119], v[20:23], v[56:59]
    s_waitcnt lgkmcnt(6)
    v_mfma_f32_16x16x32_bf16 v[48:51], a[120:123], v[24:27], v[48:51]
    ds_read_b128 v[20:23], v1 offset:8032
    v_mfma_f32_16x16x32_bf16 v[52:55], a[124:127], v[24:27], v[52:55]
    v_mfma_f32_16x16x32_bf16 v[56:59], a[128:131], v[24:27], v[56:59]
    s_waitcnt lgkmcnt(6)
    v_mfma_f32_16x16x32_bf16 v[48:51], a[132:135], v[28:31], v[48:51]
    ds_read_b128 v[24:27], v1 offset:9600
    v_mfma_f32_16x16x32_bf16 v[52:55], a[136:139], v[28:31], v[52:55]
    v_mfma_f32_16x16x32_bf16 v[56:59], a[140:143], v[28:31], v[56:59]
    s_waitcnt lgkmcnt(6)
    v_mfma_f32_16x16x32_bf16 v[48:51], a[144:147], v[32:35], v[48:51]
    ds_read_b128 v[28:31], v1 offset:11200
    v_mfma_f32_16x16x32_bf16 v[52:55], a[148:151], v[32:35], v[52:55]
    v_mfma_f32_16x16x32_bf16 v[56:59], a[152:155], v[32:35], v[56:59]
    s_waitcnt lgkmcnt(6)
    v_mfma_f32_16x16x32_bf16 v[48:51], a[156:159], v[36:39], v[48:51]
    ds_read_b128 v[32:35], v1 offset:12800
    v_mfma_f32_16x16x32_bf16 v[52:55], a[160:163], v[36:39], v[52:55]
    v_mfma_f32_16x16x32_bf16 v[56:59], a[164:167], v[36:39], v[56:59]
    s_waitcnt lgkmcnt(6)
    v_mfma_f32_16x16x32_bf16 v[48:51], a[168:171], v[40:43], v[48:51]
    ds_read_b128 v[36:39], v1 offset:9616
    v_mfma_f32_16x16x32_bf16 v[52:55], a[172:175], v[40:43], v[52:55]
    v_mfma_f32_16x16x32_bf16 v[56:59], a[176:179], v[40:43], v[56:59]
    s_waitcnt lgkmcnt(6)
    v_mfma_f32_16x16x32_bf16 v[48:51], a[180:183], v[44:47], v[48:51]
    ds_read_b128 v[40:43], v1 offset:11216
    v_mfma_f32_16x16x32_bf16 v[52:55], a[184:187], v[44:47], v[52:55]
    v_mfma_f32_16x16x32_bf16 v[56:59], a[188:191], v[44:47], v[56:59]
    s_waitcnt lgkmcnt(6)
    v_mfma_f32_16x16x32_bf16 v[48:51], a[192:195], v[16:19], v[48:51]
    ds_read_b128 v[44:47], v1 offset:12816
    v_mfma_f32_16x16x32_bf16 v[52:55], a[196:199], v[16:19], v[52:55]
    v_mfma_f32_16x16x32_bf16 v[56:59], a[200:203], v[16:19], v[56:59]
    s_waitcnt lgkmcnt(6)
    v_mfma_f32_16x16x32_bf16 v[48:51], a[204:207], v[20:23], v[48:51]
    ds_read_b128 v[16:19], v1 offset:9632
    v_mfma_f32_16x16x32_bf16 v[52:55], a[208:211], v[20:23], v[52:55]
    v_mfma_f32_16x16x32_bf16 v[56:59], a[212:215], v[20:23], v[56:59]
    s_waitcnt lgkmcnt(6)
    v_mfma_f32_16x16x32_bf16 v[48:51], a[216:219], v[24:27], v[48:51]
    ds_read_b128 v[20:23], v1 offset:11232
    v_mfma_f32_16x16x32_bf16 v[52:55], a[220:223], v[24:27], v[52:55]
    v_mfma_f32_16x16x32_bf16 v[56:59], a[224:227], v[24:27], v[56:59]
    s_waitcnt lgkmcnt(6)
    v_mfma_f32_16x16x32_bf16 v[48:51], a[228:231], v[28:31], v[48:51]
    ds_read_b128 v[24:27], v1 offset:12832
    v_mfma_f32_16x16x32_bf16 v[52:55], a[232:235], v[28:31], v[52:55]
    v_mfma_f32_16x16x32_bf16 v[56:59], a[236:239], v[28:31], v[56:59]
    s_waitcnt lgkmcnt(6)
    v_mfma_f32_16x16x32_bf16 v[48:51], a[240:243], v[32:35], v[48:51]
    ds_read_b128 v[28:31], v1 offset:256
    v_mfma_f32_16x16x32_bf16 v[52:55], a[244:247], v[32:35], v[52:55]
    v_mfma_f32_16x16x32_bf16 v[56:59], a[248:251], v[32:35], v[56:59]
    s_waitcnt lgkmcnt(6)
    v_mfma_f32_16x16x32_bf16 v[48:51], a[252:255], v[36:39], v[48:51]
    ds_read_b128 v[32:35], v1 offset:1856
    v_mfma_f32_16x16x32_bf16 v[52:55], v[180:183], v[36:39], v[52:55]
    v_mfma_f32_16x16x32_bf16 v[56:59], v[184:187], v[36:39], v[56:59]
    s_waitcnt lgkmcnt(6)
    v_mfma_f32_16x16x32_bf16 v[48:51], v[188:191], v[40:43], v[48:51]
    ds_read_b128 v[36:39], v1 offset:3456
    v_mfma_f32_16x16x32_bf16 v[52:55], v[192:195], v[40:43], v[52:55]
    v_mfma_f32_16x16x32_bf16 v[56:59], v[196:199], v[40:43], v[56:59]
    s_waitcnt lgkmcnt(6)
    v_mfma_f32_16x16x32_bf16 v[48:51], v[200:203], v[44:47], v[48:51]
    ds_read_b128 v[40:43], v1 offset:272
    v_mfma_f32_16x16x32_bf16 v[52:55], v[204:207], v[44:47], v[52:55]
    v_mfma_f32_16x16x32_bf16 v[56:59], v[208:211], v[44:47], v[56:59]
    s_waitcnt lgkmcnt(6)
    v_mfma_f32_16x16x32_bf16 v[48:51], v[212:215], v[16:19], v[48:51]
    ds_read_b128 v[44:47], v1 offset:1872
    v_mfma_f32_16x16x32_bf16 v[52:55], v[216:219], v[16:19], v[52:55]
    v_mfma_f32_16x16x32_bf16 v[56:59], v[220:223], v[16:19], v[56:59]
    s_waitcnt lgkmcnt(6)
    v_mfma_f32_16x16x32_bf16 v[48:51], v[224:227], v[20:23], v[48:51]
    ds_read_b128 v[16:19], v1 offset:3472
    v_mfma_f32_16x16x32_bf16 v[52:55], v[228:231], v[20:23], v[52:55]
    v_mfma_f32_16x16x32_bf16 v[56:59], v[232:235], v[20:23], v[56:59]
    s_waitcnt lgkmcnt(6)
    v_mfma_f32_16x16x32_bf16 v[48:51], v[236:239], v[24:27], v[48:51]
    ds_read_b128 v[20:23], v1 offset:288
    v_mfma_f32_16x16x32_bf16 v[52:55], v[240:243], v[24:27], v[52:55]
    v_mfma_f32_16x16x32_bf16 v[56:59], v[244:247], v[24:27], v[56:59]
    s_waitcnt lgkmcnt(6)
    v_mfma_f32_16x16x32_bf16 v[60:63], a[0:3], v[28:31], 0
    ds_read_b128 v[24:27], v1 offset:1888
    v_mfma_f32_16x16x32_bf16 v[64:67], a[4:7], v[28:31], 0
    v_mfma_f32_16x16x32_bf16 v[68:71], a[8:11], v[28:31], 0
    s_waitcnt lgkmcnt(6)
    v_mfma_f32_16x16x32_bf16 v[60:63], a[12:15], v[32:35], v[60:63]
    ds_read_b128 v[28:31], v1 offset:3488
    v_mfma_f32_16x16x32_bf16 v[64:67], a[16:19], v[32:35], v[64:67]
    v_mfma_f32_16x16x32_bf16 v[68:71], a[20:23], v[32:35], v[68:71]
    s_waitcnt lgkmcnt(6)
    v_mfma_f32_16x16x32_bf16 v[60:63], a[24:27], v[36:39], v[60:63]
    ds_read_b128 v[32:35], v1 offset:5056
    v_mfma_f32_16x16x32_bf16 v[64:67], a[28:31], v[36:39], v[64:67]
    v_mfma_f32_16x16x32_bf16 v[68:71], a[32:35], v[36:39], v[68:71]
    s_waitcnt lgkmcnt(6)
    v_mfma_f32_16x16x32_bf16 v[60:63], a[36:39], v[40:43], v[60:63]
    ds_read_b128 v[36:39], v1 offset:6656
    v_mfma_f32_16x16x32_bf16 v[64:67], a[40:43], v[40:43], v[64:67]
    v_mfma_f32_16x16x32_bf16 v[68:71], a[44:47], v[40:43], v[68:71]
    v_cvt_pk_bf16_f32 v248, v48, v49
    s_waitcnt lgkmcnt(6)
    v_mfma_f32_16x16x32_bf16 v[60:63], a[48:51], v[44:47], v[60:63]
    ds_read_b128 v[40:43], v1 offset:8256
    v_mfma_f32_16x16x32_bf16 v[64:67], a[52:55], v[44:47], v[64:67]
    v_mfma_f32_16x16x32_bf16 v[68:71], a[56:59], v[44:47], v[68:71]
    v_cvt_pk_bf16_f32 v249, v50, v51
    s_waitcnt lgkmcnt(6)
    v_mfma_f32_16x16x32_bf16 v[60:63], a[60:63], v[16:19], v[60:63]
    ds_read_b128 v[44:47], v1 offset:5072
    v_mfma_f32_16x16x32_bf16 v[64:67], a[64:67], v[16:19], v[64:67]
    v_mfma_f32_16x16x32_bf16 v[68:71], a[68:71], v[16:19], v[68:71]
    s_waitcnt lgkmcnt(6)
    v_mfma_f32_16x16x32_bf16 v[60:63], a[72:75], v[20:23], v[60:63]
    ds_read_b128 v[16:19], v1 offset:6672
    v_cvt_pk_bf16_f32 v250, v52, v53
    v_mfma_f32_16x16x32_bf16 v[64:67], a[76:79], v[20:23], v[64:67]
    v_mfma_f32_16x16x32_bf16 v[68:71], a[80:83], v[20:23], v[68:71]
    s_waitcnt lgkmcnt(6)
    v_mfma_f32_16x16x32_bf16 v[60:63], a[84:87], v[24:27], v[60:63]
    ds_read_b128 v[20:23], v1 offset:8272
    v_cvt_pk_bf16_f32 v251, v54, v55
    v_mfma_f32_16x16x32_bf16 v[64:67], a[88:91], v[24:27], v[64:67]
    v_mfma_f32_16x16x32_bf16 v[68:71], a[92:95], v[24:27], v[68:71]
    s_waitcnt lgkmcnt(6)
    v_mfma_f32_16x16x32_bf16 v[60:63], a[96:99], v[28:31], v[60:63]
    ds_read_b128 v[24:27], v1 offset:5088
    v_mfma_f32_16x16x32_bf16 v[64:67], a[100:103], v[28:31], v[64:67]
    v_cvt_pk_bf16_f32 v252, v56, v57
    v_mfma_f32_16x16x32_bf16 v[68:71], a[104:107], v[28:31], v[68:71]
    s_waitcnt lgkmcnt(6)
    v_mfma_f32_16x16x32_bf16 v[60:63], a[108:111], v[32:35], v[60:63]
    ds_read_b128 v[28:31], v1 offset:6688
    v_mfma_f32_16x16x32_bf16 v[64:67], a[112:115], v[32:35], v[64:67]
    v_mfma_f32_16x16x32_bf16 v[68:71], a[116:119], v[32:35], v[68:71]
    v_cvt_pk_bf16_f32 v253, v58, v59
    s_waitcnt lgkmcnt(6)
    v_mfma_f32_16x16x32_bf16 v[60:63], a[120:123], v[36:39], v[60:63]
    ds_read_b128 v[32:35], v1 offset:8288
    v_mfma_f32_16x16x32_bf16 v[64:67], a[124:127], v[36:39], v[64:67]
    v_mfma_f32_16x16x32_bf16 v[68:71], a[128:131], v[36:39], v[68:71]
    buffer_store_dwordx4 v[248:251], v3, s[20:23], s29 offen
    s_waitcnt lgkmcnt(6)
    v_mfma_f32_16x16x32_bf16 v[60:63], a[132:135], v[40:43], v[60:63]
    ds_read_b128 v[36:39], v1 offset:9856
    v_mfma_f32_16x16x32_bf16 v[64:67], a[136:139], v[40:43], v[64:67]
    v_mfma_f32_16x16x32_bf16 v[68:71], a[140:143], v[40:43], v[68:71]
    s_waitcnt lgkmcnt(6)
    v_mfma_f32_16x16x32_bf16 v[60:63], a[144:147], v[44:47], v[60:63]
    ds_read_b128 v[40:43], v1 offset:11456
    buffer_store_dwordx2 v[252:253], v4, s[20:23], s29 offen
    v_mfma_f32_16x16x32_bf16 v[64:67], a[148:151], v[44:47], v[64:67]
    v_mfma_f32_16x16x32_bf16 v[68:71], a[152:155], v[44:47], v[68:71]
    s_waitcnt lgkmcnt(6)
    v_mfma_f32_16x16x32_bf16 v[60:63], a[156:159], v[16:19], v[60:63]
    ds_read_b128 v[44:47], v1 offset:13056
    v_mfma_f32_16x16x32_bf16 v[64:67], a[160:163], v[16:19], v[64:67]
    v_mfma_f32_16x16x32_bf16 v[68:71], a[164:167], v[16:19], v[68:71]
    s_waitcnt lgkmcnt(6)
    v_mfma_f32_16x16x32_bf16 v[60:63], a[168:171], v[20:23], v[60:63]
    ds_read_b128 v[16:19], v1 offset:9872
    v_mfma_f32_16x16x32_bf16 v[64:67], a[172:175], v[20:23], v[64:67]
    v_mfma_f32_16x16x32_bf16 v[68:71], a[176:179], v[20:23], v[68:71]
    s_waitcnt lgkmcnt(6)
    v_mfma_f32_16x16x32_bf16 v[60:63], a[180:183], v[24:27], v[60:63]
    ds_read_b128 v[20:23], v1 offset:11472
    v_mfma_f32_16x16x32_bf16 v[64:67], a[184:187], v[24:27], v[64:67]
    v_mfma_f32_16x16x32_bf16 v[68:71], a[188:191], v[24:27], v[68:71]
    s_waitcnt lgkmcnt(6)
    v_mfma_f32_16x16x32_bf16 v[60:63], a[192:195], v[28:31], v[60:63]
    ds_read_b128 v[24:27], v1 offset:13072
    v_mfma_f32_16x16x32_bf16 v[64:67], a[196:199], v[28:31], v[64:67]
    v_mfma_f32_16x16x32_bf16 v[68:71], a[200:203], v[28:31], v[68:71]
    s_waitcnt lgkmcnt(6)
    v_mfma_f32_16x16x32_bf16 v[60:63], a[204:207], v[32:35], v[60:63]
    ds_read_b128 v[28:31], v1 offset:9888
    v_mfma_f32_16x16x32_bf16 v[64:67], a[208:211], v[32:35], v[64:67]
    v_mfma_f32_16x16x32_bf16 v[68:71], a[212:215], v[32:35], v[68:71]
    s_waitcnt lgkmcnt(6)
    v_mfma_f32_16x16x32_bf16 v[60:63], a[216:219], v[36:39], v[60:63]
    ds_read_b128 v[32:35], v1 offset:11488
    v_mfma_f32_16x16x32_bf16 v[64:67], a[220:223], v[36:39], v[64:67]
    v_mfma_f32_16x16x32_bf16 v[68:71], a[224:227], v[36:39], v[68:71]
    s_waitcnt lgkmcnt(6)
    v_mfma_f32_16x16x32_bf16 v[60:63], a[228:231], v[40:43], v[60:63]
    ds_read_b128 v[36:39], v1 offset:13088
    v_mfma_f32_16x16x32_bf16 v[64:67], a[232:235], v[40:43], v[64:67]
    v_mfma_f32_16x16x32_bf16 v[68:71], a[236:239], v[40:43], v[68:71]
    s_waitcnt lgkmcnt(6)
    v_mfma_f32_16x16x32_bf16 v[60:63], a[240:243], v[44:47], v[60:63]
    ds_read_b128 v[40:43], v1 offset:512
    v_mfma_f32_16x16x32_bf16 v[64:67], a[244:247], v[44:47], v[64:67]
    v_mfma_f32_16x16x32_bf16 v[68:71], a[248:251], v[44:47], v[68:71]
    s_waitcnt lgkmcnt(6)
    v_mfma_f32_16x16x32_bf16 v[60:63], a[252:255], v[16:19], v[60:63]
    ds_read_b128 v[44:47], v1 offset:2112
    v_mfma_f32_16x16x32_bf16 v[64:67], v[180:183], v[16:19], v[64:67]
    v_mfma_f32_16x16x32_bf16 v[68:71], v[184:187], v[16:19], v[68:71]
    s_waitcnt lgkmcnt(6)
    v_mfma_f32_16x16x32_bf16 v[60:63], v[188:191], v[20:23], v[60:63]
    ds_read_b128 v[16:19], v1 offset:3712
    v_mfma_f32_16x16x32_bf16 v[64:67], v[192:195], v[20:23], v[64:67]
    v_mfma_f32_16x16x32_bf16 v[68:71], v[196:199], v[20:23], v[68:71]
    s_waitcnt lgkmcnt(6)
    v_mfma_f32_16x16x32_bf16 v[60:63], v[200:203], v[24:27], v[60:63]
    ds_read_b128 v[20:23], v1 offset:528
    v_mfma_f32_16x16x32_bf16 v[64:67], v[204:207], v[24:27], v[64:67]
    v_mfma_f32_16x16x32_bf16 v[68:71], v[208:211], v[24:27], v[68:71]
    s_waitcnt lgkmcnt(6)
    v_mfma_f32_16x16x32_bf16 v[60:63], v[212:215], v[28:31], v[60:63]
    ds_read_b128 v[24:27], v1 offset:2128
    v_mfma_f32_16x16x32_bf16 v[64:67], v[216:219], v[28:31], v[64:67]
    v_mfma_f32_16x16x32_bf16 v[68:71], v[220:223], v[28:31], v[68:71]
    s_waitcnt lgkmcnt(6)
    v_mfma_f32_16x16x32_bf16 v[60:63], v[224:227], v[32:35], v[60:63]
    ds_read_b128 v[28:31], v1 offset:3728
    v_mfma_f32_16x16x32_bf16 v[64:67], v[228:231], v[32:35], v[64:67]
    v_mfma_f32_16x16x32_bf16 v[68:71], v[232:235], v[32:35], v[68:71]
    s_waitcnt lgkmcnt(6)
    v_mfma_f32_16x16x32_bf16 v[60:63], v[236:239], v[36:39], v[60:63]
    ds_read_b128 v[32:35], v1 offset:544
    v_mfma_f32_16x16x32_bf16 v[64:67], v[240:243], v[36:39], v[64:67]
    v_mfma_f32_16x16x32_bf16 v[68:71], v[244:247], v[36:39], v[68:71]
    s_waitcnt lgkmcnt(6)
    v_mfma_f32_16x16x32_bf16 v[72:75], a[0:3], v[40:43], 0
    ds_read_b128 v[36:39], v1 offset:2144
    v_mfma_f32_16x16x32_bf16 v[76:79], a[4:7], v[40:43], 0
    v_mfma_f32_16x16x32_bf16 v[80:83], a[8:11], v[40:43], 0
    s_waitcnt lgkmcnt(6)
    v_mfma_f32_16x16x32_bf16 v[72:75], a[12:15], v[44:47], v[72:75]
    ds_read_b128 v[40:43], v1 offset:3744
    v_mfma_f32_16x16x32_bf16 v[76:79], a[16:19], v[44:47], v[76:79]
    v_mfma_f32_16x16x32_bf16 v[80:83], a[20:23], v[44:47], v[80:83]
    s_waitcnt lgkmcnt(6)
    v_mfma_f32_16x16x32_bf16 v[72:75], a[24:27], v[16:19], v[72:75]
    ds_read_b128 v[44:47], v1 offset:5312
    v_mfma_f32_16x16x32_bf16 v[76:79], a[28:31], v[16:19], v[76:79]
    v_mfma_f32_16x16x32_bf16 v[80:83], a[32:35], v[16:19], v[80:83]
    s_waitcnt lgkmcnt(6)
    v_mfma_f32_16x16x32_bf16 v[72:75], a[36:39], v[20:23], v[72:75]
    ds_read_b128 v[16:19], v1 offset:6912
    v_mfma_f32_16x16x32_bf16 v[76:79], a[40:43], v[20:23], v[76:79]
    v_cvt_pk_bf16_f32 v248, v60, v61
    v_mfma_f32_16x16x32_bf16 v[80:83], a[44:47], v[20:23], v[80:83]
    s_waitcnt lgkmcnt(6)
    v_mfma_f32_16x16x32_bf16 v[72:75], a[48:51], v[24:27], v[72:75]
    ds_read_b128 v[20:23], v1 offset:8512
    v_mfma_f32_16x16x32_bf16 v[76:79], a[52:55], v[24:27], v[76:79]
    v_cvt_pk_bf16_f32 v249, v62, v63
    v_mfma_f32_16x16x32_bf16 v[80:83], a[56:59], v[24:27], v[80:83]
    s_waitcnt lgkmcnt(6)
    v_mfma_f32_16x16x32_bf16 v[72:75], a[60:63], v[28:31], v[72:75]
    ds_read_b128 v[24:27], v1 offset:5328
    v_mfma_f32_16x16x32_bf16 v[76:79], a[64:67], v[28:31], v[76:79]
    v_mfma_f32_16x16x32_bf16 v[80:83], a[68:71], v[28:31], v[80:83]
    v_cvt_pk_bf16_f32 v250, v64, v65
    s_waitcnt lgkmcnt(6)
    v_mfma_f32_16x16x32_bf16 v[72:75], a[72:75], v[32:35], v[72:75]
    ds_read_b128 v[28:31], v1 offset:6928
    v_mfma_f32_16x16x32_bf16 v[76:79], a[76:79], v[32:35], v[76:79]
    v_mfma_f32_16x16x32_bf16 v[80:83], a[80:83], v[32:35], v[80:83]
    v_cvt_pk_bf16_f32 v251, v66, v67
    s_waitcnt lgkmcnt(6)
    v_mfma_f32_16x16x32_bf16 v[72:75], a[84:87], v[36:39], v[72:75]
    ds_read_b128 v[32:35], v1 offset:8528
    v_mfma_f32_16x16x32_bf16 v[76:79], a[88:91], v[36:39], v[76:79]
    v_mfma_f32_16x16x32_bf16 v[80:83], a[92:95], v[36:39], v[80:83]
    s_waitcnt lgkmcnt(6)
    v_mfma_f32_16x16x32_bf16 v[72:75], a[96:99], v[40:43], v[72:75]
    ds_read_b128 v[36:39], v1 offset:5344
    v_cvt_pk_bf16_f32 v252, v68, v69
    v_mfma_f32_16x16x32_bf16 v[76:79], a[100:103], v[40:43], v[76:79]
    v_mfma_f32_16x16x32_bf16 v[80:83], a[104:107], v[40:43], v[80:83]
    s_waitcnt lgkmcnt(6)
    v_mfma_f32_16x16x32_bf16 v[72:75], a[108:111], v[44:47], v[72:75]
    ds_read_b128 v[40:43], v1 offset:6944
    v_mfma_f32_16x16x32_bf16 v[76:79], a[112:115], v[44:47], v[76:79]
    v_cvt_pk_bf16_f32 v253, v70, v71
    v_mfma_f32_16x16x32_bf16 v[80:83], a[116:119], v[44:47], v[80:83]
    s_waitcnt lgkmcnt(6)
    v_mfma_f32_16x16x32_bf16 v[72:75], a[120:123], v[16:19], v[72:75]
    ds_read_b128 v[44:47], v1 offset:8544
    v_mfma_f32_16x16x32_bf16 v[76:79], a[124:127], v[16:19], v[76:79]
    buffer_store_dwordx4 v[248:251], v3, s[20:23], s47 offen
    v_mfma_f32_16x16x32_bf16 v[80:83], a[128:131], v[16:19], v[80:83]
    s_waitcnt lgkmcnt(6)
    v_mfma_f32_16x16x32_bf16 v[72:75], a[132:135], v[20:23], v[72:75]
    ds_read_b128 v[16:19], v1 offset:10112
    v_mfma_f32_16x16x32_bf16 v[76:79], a[136:139], v[20:23], v[76:79]
    v_mfma_f32_16x16x32_bf16 v[80:83], a[140:143], v[20:23], v[80:83]
    buffer_store_dwordx2 v[252:253], v4, s[20:23], s47 offen
    s_waitcnt lgkmcnt(6)
    v_mfma_f32_16x16x32_bf16 v[72:75], a[144:147], v[24:27], v[72:75]
    ds_read_b128 v[20:23], v1 offset:11712
    v_mfma_f32_16x16x32_bf16 v[76:79], a[148:151], v[24:27], v[76:79]
    v_mfma_f32_16x16x32_bf16 v[80:83], a[152:155], v[24:27], v[80:83]
    s_waitcnt lgkmcnt(6)
    v_mfma_f32_16x16x32_bf16 v[72:75], a[156:159], v[28:31], v[72:75]
    ds_read_b128 v[24:27], v1 offset:13312
    v_mfma_f32_16x16x32_bf16 v[76:79], a[160:163], v[28:31], v[76:79]
    v_mfma_f32_16x16x32_bf16 v[80:83], a[164:167], v[28:31], v[80:83]
    s_waitcnt lgkmcnt(6)
    v_mfma_f32_16x16x32_bf16 v[72:75], a[168:171], v[32:35], v[72:75]
    ds_read_b128 v[28:31], v1 offset:10128
    v_mfma_f32_16x16x32_bf16 v[76:79], a[172:175], v[32:35], v[76:79]
    v_mfma_f32_16x16x32_bf16 v[80:83], a[176:179], v[32:35], v[80:83]
    s_waitcnt lgkmcnt(6)
    v_mfma_f32_16x16x32_bf16 v[72:75], a[180:183], v[36:39], v[72:75]
    ds_read_b128 v[32:35], v1 offset:11728
    v_mfma_f32_16x16x32_bf16 v[76:79], a[184:187], v[36:39], v[76:79]
    v_mfma_f32_16x16x32_bf16 v[80:83], a[188:191], v[36:39], v[80:83]
    s_waitcnt lgkmcnt(6)
    v_mfma_f32_16x16x32_bf16 v[72:75], a[192:195], v[40:43], v[72:75]
    ds_read_b128 v[36:39], v1 offset:13328
    v_mfma_f32_16x16x32_bf16 v[76:79], a[196:199], v[40:43], v[76:79]
    v_mfma_f32_16x16x32_bf16 v[80:83], a[200:203], v[40:43], v[80:83]
    s_waitcnt lgkmcnt(6)
    v_mfma_f32_16x16x32_bf16 v[72:75], a[204:207], v[44:47], v[72:75]
    ds_read_b128 v[40:43], v1 offset:10144
    v_mfma_f32_16x16x32_bf16 v[76:79], a[208:211], v[44:47], v[76:79]
    v_mfma_f32_16x16x32_bf16 v[80:83], a[212:215], v[44:47], v[80:83]
    s_waitcnt lgkmcnt(6)
    v_mfma_f32_16x16x32_bf16 v[72:75], a[216:219], v[16:19], v[72:75]
    ds_read_b128 v[44:47], v1 offset:11744
    v_mfma_f32_16x16x32_bf16 v[76:79], a[220:223], v[16:19], v[76:79]
    v_mfma_f32_16x16x32_bf16 v[80:83], a[224:227], v[16:19], v[80:83]
    s_waitcnt lgkmcnt(6)
    v_mfma_f32_16x16x32_bf16 v[72:75], a[228:231], v[20:23], v[72:75]
    ds_read_b128 v[16:19], v1 offset:13344
    v_mfma_f32_16x16x32_bf16 v[76:79], a[232:235], v[20:23], v[76:79]
    v_mfma_f32_16x16x32_bf16 v[80:83], a[236:239], v[20:23], v[80:83]
    s_waitcnt lgkmcnt(6)
    v_mfma_f32_16x16x32_bf16 v[72:75], a[240:243], v[24:27], v[72:75]
    v_mfma_f32_16x16x32_bf16 v[76:79], a[244:247], v[24:27], v[76:79]
    v_mfma_f32_16x16x32_bf16 v[80:83], a[248:251], v[24:27], v[80:83]
    s_waitcnt lgkmcnt(5)
    v_mfma_f32_16x16x32_bf16 v[72:75], a[252:255], v[28:31], v[72:75]
    v_mfma_f32_16x16x32_bf16 v[76:79], v[180:183], v[28:31], v[76:79]
    v_mfma_f32_16x16x32_bf16 v[80:83], v[184:187], v[28:31], v[80:83]
    s_waitcnt lgkmcnt(4)
    v_mfma_f32_16x16x32_bf16 v[72:75], v[188:191], v[32:35], v[72:75]
    v_mfma_f32_16x16x32_bf16 v[76:79], v[192:195], v[32:35], v[76:79]
    v_mfma_f32_16x16x32_bf16 v[80:83], v[196:199], v[32:35], v[80:83]
    s_waitcnt lgkmcnt(3)
    v_mfma_f32_16x16x32_bf16 v[72:75], v[200:203], v[36:39], v[72:75]
    v_mfma_f32_16x16x32_bf16 v[76:79], v[204:207], v[36:39], v[76:79]
    v_mfma_f32_16x16x32_bf16 v[80:83], v[208:211], v[36:39], v[80:83]
    s_waitcnt lgkmcnt(2)
    v_mfma_f32_16x16x32_bf16 v[72:75], v[212:215], v[40:43], v[72:75]
    v_mfma_f32_16x16x32_bf16 v[76:79], v[216:219], v[40:43], v[76:79]
    v_mfma_f32_16x16x32_bf16 v[80:83], v[220:223], v[40:43], v[80:83]
    s_waitcnt lgkmcnt(1)
    v_mfma_f32_16x16x32_bf16 v[72:75], v[224:227], v[44:47], v[72:75]
    v_mfma_f32_16x16x32_bf16 v[76:79], v[228:231], v[44:47], v[76:79]
    v_mfma_f32_16x16x32_bf16 v[80:83], v[232:235], v[44:47], v[80:83]
    s_waitcnt lgkmcnt(0)
    v_mfma_f32_16x16x32_bf16 v[72:75], v[236:239], v[16:19], v[72:75]
    v_mfma_f32_16x16x32_bf16 v[76:79], v[240:243], v[16:19], v[76:79]
    v_mfma_f32_16x16x32_bf16 v[80:83], v[244:247], v[16:19], v[80:83]
    s_add_u32 s55, s29, 6144
    s_add_u32 s29, s29, 147456
    v_add_u32 v1, 9600, v1
    s_add_u32 s31, s31, 1
    s_nop 1
    v_cvt_pk_bf16_f32 v248, v72, v73
    v_cvt_pk_bf16_f32 v249, v74, v75
    v_cvt_pk_bf16_f32 v250, v76, v77
    v_cvt_pk_bf16_f32 v251, v78, v79
    v_cvt_pk_bf16_f32 v252, v80, v81
    v_cvt_pk_bf16_f32 v253, v82, v83
    buffer_store_dwordx4 v[248:251], v3, s[20:23], s55 offen
    buffer_store_dwordx2 v[252:253], v4, s[20:23], s55 offen
L_end:
    s_endpgm
.section .rodata,"a"
.p2align 6
.amdhsa_kernel standalone__detection_seg_fpn_lateral__vision_kernel
  .amdhsa_next_free_vgpr 512
  .amdhsa_next_free_sgpr 102
  .amdhsa_accum_offset 256
  .amdhsa_group_segment_fixed_size 0
  .amdhsa_kernarg_size 56
  .amdhsa_user_sgpr_count 2
  .amdhsa_user_sgpr_kernarg_segment_ptr 1
  .amdhsa_system_sgpr_workgroup_id_x 1
.end_amdhsa_kernel
```
